```python
import torch

def _softmax(x, axis=-1):
    return torch.softmax(x, dim=axis)
def _gelu(x):
    return torch.nn.functional.gelu(x, approximate="tanh")
def _silu(x):
    return torch.nn.functional.silu(x)
def _sigmoid(x):
    return torch.sigmoid(x)
def _layernorm(x, axis=-1, eps=1e-5):
    m = x.mean(dim=axis, keepdim=True)
    v = x.var(dim=axis, keepdim=True, unbiased=False)
    return (x - m) / torch.sqrt(v + eps)
def _scatter_add(tgt, idx, src, axis=0):
    return tgt.clone().index_add_(axis, idx, src)
def _segment_sum(src, seg, n):
    out = torch.zeros((n,) + src.shape[1:], dtype=src.dtype)
    return out.index_add_(0, seg, src)
def _pad(x, pw):
    flat = tuple(v for pair in reversed(pw) for v in pair)
    return torch.nn.functional.pad(x, flat)

kernel_name = 'sequential_preLN__spectral_fnet__dense_activation_squared_relu__prompt'

def setup_inputs():

    _w = (lambda a: (lambda t: t.to(torch.bfloat16) if t.is_floating_point() else t)(torch.as_tensor(a)))
    def _A_setup():
        B, S, D = 1, 2048, 1024
        ns = torch.arange(S)[:, None] * torch.arange(S)[None, :]
        nd = torch.arange(D)[:, None] * torch.arange(D)[None, :]
        Ws_re = torch.cos(-2.0 * torch.pi * ns / S).to(float)
        Ws_im = torch.sin(-2.0 * torch.pi * ns / S).to(float)
        Wd_re = torch.cos(-2.0 * torch.pi * nd / D).to(float)
        Wd_im = torch.sin(-2.0 * torch.pi * nd / D).to(float)
        return {
            "x": _w((lambda *s: torch.randn(*s, dtype=torch.bfloat16) * 0.05)(B, S, D)),
            "dft_seq_re": _w(Ws_re),
            "dft_seq_im": _w(Ws_im),
            "dft_hid_re": _w(Wd_re),
            "dft_hid_im": _w(Wd_im),
        }
    _A_in = _A_setup()

    def _B_setup():
        B, S, D, F = 1, 2048, 1024, 3584
        return {
            "x": _w((lambda *s: torch.randn(*s, dtype=torch.bfloat16) * 0.05)(B, S, D)),
            "w1": _w((lambda *s: torch.randn(*s, dtype=torch.bfloat16) * 0.2)(D, F)),
            "b1": _w((lambda *s: torch.randn(*s, dtype=torch.bfloat16) * 0.2)(F)),
            "w2": _w((lambda *s: torch.randn(*s, dtype=torch.bfloat16) * 0.2)(F, D)),
            "b2": _w((lambda *s: torch.randn(*s, dtype=torch.bfloat16) * 0.2)(D)),
        }
    _B_in = _B_setup()

    return {
        "A_x": _A_in["x"],
        "A_dft_seq_re": _A_in["dft_seq_re"],
        "A_dft_seq_im": _A_in["dft_seq_im"],
        "A_dft_hid_re": _A_in["dft_hid_re"],
        "A_dft_hid_im": _A_in["dft_hid_im"],
        "B_x": _B_in["x"],
        "B_w1": _B_in["w1"],
        "B_b1": _B_in["b1"],
        "B_w2": _B_in["w2"],
        "B_b2": _B_in["b2"],
    }

def reference(A_x, A_dft_seq_re, A_dft_seq_im, A_dft_hid_re, A_dft_hid_im, B_x, B_w1, B_b1, B_w2, B_b2):
    def _A_ref(x, dft_seq_re, dft_seq_im, dft_hid_re, dft_hid_im):
        a = torch.einsum("bsd,ed->bse", x, dft_hid_re)
        b = torch.einsum("bsd,ed->bse", x, dft_hid_im)
        y = torch.einsum("ts,bse->bte", dft_seq_re, a) - torch.einsum("ts,bse->bte", dft_seq_im, b)
        return y

    def _B_ref(x, w1, b1, w2, b2):
        h = torch.einsum("bsd,df->bsf", x, w1) + b1
        zero = torch.zeros_like(h)
        r = torch.where(h > zero, h, zero)
        h = r * r
        out = torch.einsum("bsf,fd->bsd", h, w2) + b2
        return out

    x = A_x
    h = x + _A_ref(_layernorm(x, axis=-1), A_dft_seq_re, A_dft_seq_im, A_dft_hid_re, A_dft_hid_im)
    h2 = h + _B_ref(_layernorm(h, axis=-1), B_w1, B_b1, B_w2, B_b2)
    return h2
```

```asm
; @launch kernel=fa_kernel grid=(256,1,1) block=(256,1,1) lds=54848
; @launch kernel=m_kernel grid=(256,1,1) block=(512,1,1) lds=153088
.amdgcn_target "amdgcn-amd-amdhsa--gfx950"
.text
.globl fa_kernel
.p2align 8
.type fa_kernel,@function
fa_kernel:
    s_cmp_ge_u32 s2, 256
    s_cbranch_scc1 fa_kernel_end
    s_load_dwordx2 s[6:7], s[0:1], 0
    s_load_dwordx2 s[4:5], s[0:1], 96
    s_load_dwordx2 s[8:9], s[0:1], 48
    s_load_dwordx2 s[60:61], s[0:1], 64
    s_getpc_b64 s[36:37]
    s_mov_b32 s38, CODE_END-fa_kernel-64
    s_mov_b32 s39, 0x20000
    s_lshr_b32 s13, s2, 3
    s_lshl_b32 s13, s13, 7
    v_lshlrev_b32 v4, 12, v0
    buffer_load_dword v88, v4, s[36:39], s13 offen
    v_lshrrev_b32 v2, 6, v0
    v_and_b32 v1, 63, v0
    s_and_b32 s13, s2, 7
    v_readfirstlane_b32 s12, v2
    s_lshr_b32 s14, s2, 3
    s_and_b32 s11, s14, 1
    s_sub_u32 s15, 16, s13
    s_cmp_eq_u32 s13, 0
    s_cselect_b32 s15, 8, s15
    s_bitcmp1_b32 s14, 1
    s_cselect_b32 s10, s15, s13
    s_lshr_b32 s15, s14, 2
    s_lshl_b32 s15, s15, 4
    s_add_u32 s10, s10, s15
    v_lshrrev_b32 v4, 5, v1
    v_lshlrev_b32 v4, 1, v4
    v_xor_b32 v4, v4, v1
    v_lshlrev_b32 v14, 4, v4
    s_lshl_b32 s13, s12, 9
    s_add_u32 s13, s13, s10
    s_lshl_b32 s63, s13, 2
    s_lshl_b32 s13, s13, 11
    s_mul_i32 s14, s12, 8448
    v_and_b32 v2, 15, v1
    v_lshrrev_b32 v3, 4, v1
    s_lshl_b32 s43, s11, 4
    s_add_u32 s43, s43, 1
    v_and_b32 v5, 7, v2
    v_add_u32 v5, s43, v5
    v_cvt_f32_u32 v5, v5
    v_and_b32 v6, 8, v2
    v_cvt_f32_u32 v7, v3
    v_cvt_f32_u32 v8, v6
    v_mul_f32 v9, 0x3d000000, v5
    v_mul_f32 v8, 0x3d000000, v8
    v_mul_f32 v12, 0x41000000, v7
    v_fmac_f32 v8, v12, v9
    v_mov_b32 v13, v8
    v_cos_f32 v10, v8
    v_add_f32 v8, v8, v9
    v_cos_f32 v11, v8
    s_nop 0
    v_cvt_pk_bf16_f32 v16, v10, v11
    v_add_f32 v8, v8, v9
    v_cos_f32 v10, v8
    v_add_f32 v8, v8, v9
    v_cos_f32 v11, v8
    s_nop 0
    v_cvt_pk_bf16_f32 v17, v10, v11
    v_add_f32 v8, v8, v9
    v_cos_f32 v10, v8
    v_add_f32 v8, v8, v9
    v_cos_f32 v11, v8
    s_nop 0
    v_cvt_pk_bf16_f32 v18, v10, v11
    v_add_f32 v8, v8, v9
    v_cos_f32 v10, v8
    v_add_f32 v8, v8, v9
    v_cos_f32 v11, v8
    s_nop 0
    v_cvt_pk_bf16_f32 v19, v10, v11
    s_waitcnt lgkmcnt(0)
    s_mov_b32 s20, s6
    s_mov_b32 s21, s7
    s_mov_b32 s22, 4194304
    s_mov_b32 s23, 0x20000
    s_add_u32 m0, s14, 0
    s_nop 0
    buffer_load_dwordx4 v14, s[20:23], s13 offen nt lds
    buffer_load_dwordx4 v14, s[20:23], s13 offen offset:1024 nt lds
    s_add_u32 s13, s13, 262144
    s_add_u32 m0, s14, 2112
    s_nop 0
    buffer_load_dwordx4 v14, s[20:23], s13 offen nt lds
    buffer_load_dwordx4 v14, s[20:23], s13 offen offset:1024 nt lds
    s_add_u32 s13, s13, 262144
    s_add_u32 m0, s14, 4224
    s_nop 0
    buffer_load_dwordx4 v14, s[20:23], s13 offen nt lds
    buffer_load_dwordx4 v14, s[20:23], s13 offen offset:1024 nt lds
    s_add_u32 s13, s13, 262144
    s_add_u32 m0, s14, 6336
    s_nop 0
    buffer_load_dwordx4 v14, s[20:23], s13 offen nt lds
    buffer_load_dwordx4 v14, s[20:23], s13 offen offset:1024 nt lds
    s_mov_b32 s24, s8
    s_mov_b32 s25, s9
    s_mov_b32 s26, 7340032
    s_mov_b32 s27, 0x20000
    v_lshlrev_b32 v15, 7, v0
    v_cmp_gt_u32 vcc, 224, v0
    s_nop 1
    v_cndmask_b32 v15, 4.0, v15, vcc
    s_mul_i32 s15, s2, 28672
    buffer_load_dword v89, v15, s[24:27], s15 offen
    v_add_f32 v9, 0x3e800000, v9
    v_cos_f32 v10, v13
    v_add_f32 v13, v13, v9
    v_cos_f32 v11, v13
    s_nop 0
    v_cvt_pk_bf16_f32 v20, v10, v11
    v_add_f32 v13, v13, v9
    v_cos_f32 v10, v13
    v_add_f32 v13, v13, v9
    v_cos_f32 v11, v13
    s_nop 0
    v_cvt_pk_bf16_f32 v21, v10, v11
    v_add_f32 v13, v13, v9
    v_cos_f32 v10, v13
    v_add_f32 v13, v13, v9
    v_cos_f32 v11, v13
    s_nop 0
    v_cvt_pk_bf16_f32 v22, v10, v11
    v_add_f32 v13, v13, v9
    v_cos_f32 v10, v13
    v_add_f32 v13, v13, v9
    v_cos_f32 v11, v13
    s_nop 0
    v_cvt_pk_bf16_f32 v23, v10, v11
    v_lshlrev_b32 v9, 28, v6
    v_lshrrev_b32 v10, 16, v9
    v_or_b32 v72, v9, v10
    v_mul_f32 v12, 4.0, v7
    v_mul_f32 v13, 0x3a800000, v5
    v_xor_b32 v15, v9, v13
    v_mul_f32 v8, v12, v15
    v_cos_f32 v24, v8
    v_sin_f32 v40, v8
    v_add_f32 v8, v8, v15
    v_cos_f32 v25, v8
    v_sin_f32 v41, v8
    v_add_f32 v8, v8, v15
    v_cos_f32 v26, v8
    v_sin_f32 v42, v8
    v_add_f32 v8, v8, v15
    v_cos_f32 v27, v8
    v_sin_f32 v43, v8
    v_fmac_f32 v8, 0x41500000, v15
    v_cos_f32 v28, v8
    v_sin_f32 v44, v8
    v_add_f32 v8, v8, v15
    v_cos_f32 v29, v8
    v_sin_f32 v45, v8
    v_add_f32 v8, v8, v15
    v_cos_f32 v30, v8
    v_sin_f32 v46, v8
    v_add_f32 v8, v8, v15
    v_cos_f32 v31, v8
    v_sin_f32 v47, v8
    v_add_f32 v5, 0x41000000, v5
    v_mul_f32 v13, 0x3a800000, v5
    v_xor_b32 v15, v9, v13
    v_mul_f32 v8, v12, v15
    v_cos_f32 v32, v8
    v_sin_f32 v48, v8
    v_add_f32 v8, v8, v15
    v_cos_f32 v33, v8
    v_sin_f32 v49, v8
    v_add_f32 v8, v8, v15
    v_cos_f32 v34, v8
    v_sin_f32 v50, v8
    v_add_f32 v8, v8, v15
    v_cos_f32 v35, v8
    v_sin_f32 v51, v8
    v_fmac_f32 v8, 0x41500000, v15
    v_cos_f32 v36, v8
    v_sin_f32 v52, v8
    v_add_f32 v8, v8, v15
    v_cos_f32 v37, v8
    v_sin_f32 v53, v8
    v_add_f32 v8, v8, v15
    v_cos_f32 v38, v8
    v_sin_f32 v54, v8
    v_add_f32 v8, v8, v15
    v_cos_f32 v39, v8
    v_sin_f32 v55, v8
    s_cmp_eq_u32 s11, 1
    s_cselect_b32 s44, 0xc2000000, 0
    v_mov_b32 v73, s44
    v_cmp_eq_u32 vcc, 7, v2
    s_nop 1
    v_cndmask_b32 v73, 0, v73, vcc
    v_cvt_f32_u32 v5, v2
    v_mul_f32 v13, 0x3d000000, v5
    v_mul_f32 v8, v12, v13
    v_cos_f32 v10, v8
    v_sin_f32 v14, v8
    v_add_f32 v8, v8, v13
    v_cos_f32 v11, v8
    v_sin_f32 v15, v8
    v_cvt_pk_bf16_f32 v56, v10, v11
    v_cvt_pk_bf16_f32 v60, v14, v15
    v_add_f32 v8, v8, v13
    v_cos_f32 v10, v8
    v_sin_f32 v14, v8
    v_add_f32 v8, v8, v13
    v_cos_f32 v11, v8
    v_sin_f32 v15, v8
    v_cvt_pk_bf16_f32 v57, v10, v11
    v_cvt_pk_bf16_f32 v61, v14, v15
    v_fmac_f32 v8, 0x41500000, v13
    v_cos_f32 v10, v8
    v_sin_f32 v14, v8
    v_add_f32 v8, v8, v13
    v_cos_f32 v11, v8
    v_sin_f32 v15, v8
    v_cvt_pk_bf16_f32 v58, v10, v11
    v_cvt_pk_bf16_f32 v62, v14, v15
    v_add_f32 v8, v8, v13
    v_cos_f32 v10, v8
    v_sin_f32 v14, v8
    v_add_f32 v8, v8, v13
    v_cos_f32 v11, v8
    v_sin_f32 v15, v8
    v_cvt_pk_bf16_f32 v59, v10, v11
    v_cvt_pk_bf16_f32 v63, v14, v15
    v_mov_b32 v76, 0x3f803f80
    v_mov_b32 v77, 0x3f803f80
    v_mov_b32 v78, 0x3f803f80
    v_mov_b32 v79, 0x3f803f80
    v_lshrrev_b32 v10, 2, v2
    v_and_b32 v11, 3, v2
    v_mul_u32_u24 v12, 2112, v10
    v_mul_u32_u24 v13, 528, v11
    v_add3_u32 v12, v12, v13, s14
    v_and_b32 v13, 1, v3
    v_lshl_add_u32 v12, v13, 8, v12
    v_lshrrev_b32 v15, 1, v3
    v_lshl_add_u32 v108, v15, 7, v12
    v_xor_b32 v109, 16, v108
    v_xor_b32 v110, 32, v108
    v_xor_b32 v111, 48, v108
    v_lshlrev_b32 v12, 6, v10
    v_lshl_add_u32 v12, v3, 9, v12
    v_lshl_add_u32 v12, v11, 3, v12
    v_lshl_add_u32 v12, v13, 5, v12
    v_add_u32 v90, s14, v12
    v_xor_b32 v91, 32, v90
    s_mul_i32 s15, s12, 5248
    s_add_u32 s15, s15, 33792
    v_mul_u32_u24 v92, 80, v2
    v_lshl_add_u32 v92, v3, 4, v92
    v_add_u32 v92, s15, v92
    v_mul_u32_u24 v98, 2112, v10
    v_add_u32 v98, s14, v98
    v_mul_u32_u24 v99, 1312, v10
    v_and_b32 v12, 1, v1
    v_mul_u32_u24 v12, 640, v12
    v_add3_u32 v99, v99, v12, s15
    v_cmp_eq_u32 s[46:47], 1, v11
    v_cmp_eq_u32 s[48:49], 2, v11
    v_cmp_eq_u32 s[50:51], 3, v11
    v_cmp_eq_u32 s[52:53], v10, v3
    s_cmp_eq_u32 s11, 0
    s_cselect_b32 s16, 8192, 0
    s_add_u32 s32, s4, 28573696
    s_addc_u32 s33, s5, 0
    s_mov_b32 s34, s16
    s_mov_b32 s35, 0x20000
    s_mov_b32 s28, s4
    s_mov_b32 s29, s5
    s_mov_b32 s30, 4194304
    s_mov_b32 s31, 0x20000
    s_add_u32 s36, s4, 4718592
    s_addc_u32 s37, s5, 0
    s_mov_b32 s38, 131072
    s_mov_b32 s39, 0x20000
    s_lshr_b32 s65, s12, 1
    s_cmp_lg_u32 s65, 0
    s_cselect_b32 s44, 0.25, 0
    v_lshlrev_b32 v8, 9, v3
    v_add_u32 v8, s10, v8
    v_cvt_f32_u32 v8, v8
    v_mul_f32 v13, 0x3a000000, v5
    v_fma_f32 v8, v8, v13, s44
    v_mul_f32 v13, 0x3d800000, v5
    v_cos_f32 v64, v8
    v_sin_f32 v68, v8
    v_add_f32 v8, v8, v13
    v_cos_f32 v65, v8
    v_sin_f32 v69, v8
    v_add_f32 v8, v8, v13
    v_cos_f32 v66, v8
    v_sin_f32 v70, v8
    v_add_f32 v8, v8, v13
    v_cos_f32 v67, v8
    v_sin_f32 v71, v8
    v_lshl_add_u32 v12, v3, 2, v10
    v_mul_u32_u24 v12, 1312, v12
    v_add_u32 v97, 33856, v12
    v_lshl_add_u32 v12, v11, 3, v12
    s_and_b32 s15, s12, 1
    s_lshl_b32 s16, s15, 5
    s_add_u32 s16, s16, 33792
    v_add_u32 v93, s16, v12
    v_lshlrev_b32 v94, 20, v3
    s_lshl_b32 s16, s15, 2
    s_add_u32 s16, s16, s10
    v_add_u32 v12, s16, v10
    v_and_b32 v12, 7, v12
    v_lshl_add_u32 v94, v12, 7, v94
    v_lshl_add_u32 v94, v11, 4, v94
    s_lshl_b32 s66, s65, 17
    s_lshl_b32 s16, s10, 10
    s_add_u32 s66, s66, s16
    s_lshl_b32 s16, s11, 6
    s_add_u32 s66, s66, s16
    s_lshl_b32 s16, s15, 2
    s_add_u32 s16, s16, 1
    v_add_u32 v12, s16, v10
    v_lshlrev_b32 v96, 14, v3
    v_lshl_add_u32 v95, v12, 9, v96
    v_cmp_gt_u32 vcc, 8, v12
    s_nop 0
    s_and_b64 vcc, vcc, s[50:51]
    v_cndmask_b32 v95, 4.0, v95, vcc
    v_lshl_add_u32 v96, v2, 16, v96
    s_lshl_b32 s16, s15, 1
    v_or_b32 v12, s16, v2
    v_cmp_gt_u32 vcc, 2, v12
    s_nop 1
    v_cndmask_b32 v96, 4.0, v96, vcc
    s_lshl_b32 s67, s65, 7
    s_add_u32 s67, s67, s10
    s_lshl_b32 s67, s67, 1
    s_add_u32 s24, s4, 39845888
    s_addc_u32 s25, s5, 0
    s_mov_b32 s26, 262144
    s_mov_b32 s27, 0x20000
    v_lshlrev_b32 v12, 7, v0
    v_cmp_gt_u32 vcc, 8, v0
    s_nop 1
    v_cndmask_b32 v12, 4.0, v12, vcc
    s_mul_i32 s15, s2, 1024
    v_mov_b32 v13, 0
    buffer_store_dword v13, v12, s[24:27], s15 offen
    s_mov_b32 s24, s60
    s_mov_b32 s25, s61
    s_mov_b32 s26, 7340032
    s_mov_b32 s27, 0x20000
    v_lshrrev_b32 v12, 4, v0
    s_mul_i32 s15, s2, 14
    v_add_u32 v12, s15, v12
    v_and_b32 v13, 8, v0
    v_and_b32 v14, 7, v0
    v_lshlrev_b32 v14, 4, v14
    v_lshl_add_u32 v14, v12, 11, v14
    v_add_u32 v12, v12, v13
    v_and_b32 v12, 15, v12
    v_and_b32 v15, 7, v12
    v_cmp_eq_u32 vcc, 3, v15
    v_xor_b32 v15, 4, v12
    s_nop 0
    v_cndmask_b32 v12, v12, v15, vcc
    v_lshl_add_u32 v104, v12, 7, v14
    v_lshl_add_u32 v14, v13, 7, v14
    v_cmp_gt_u32 vcc, 224, v0
    s_nop 1
    v_cndmask_b32 v14, 4.0, v14, vcc
    v_cndmask_b32 v104, 4.0, v104, vcc
    buffer_load_dwordx4 v[100:103], v14, s[24:27], 0 offen offset:384
    s_waitcnt vmcnt(3)
    ds_read_b64_tr_b16 v[208:209], v90 offset:0
    ds_read_b64_tr_b16 v[210:211], v90 offset:256
    ds_read_b64_tr_b16 v[212:213], v91 offset:0
    ds_read_b64_tr_b16 v[214:215], v91 offset:256
    ds_read_b64_tr_b16 v[216:217], v90 offset:2112
    ds_read_b64_tr_b16 v[218:219], v90 offset:2368
    ds_read_b64_tr_b16 v[220:221], v91 offset:2112
    ds_read_b64_tr_b16 v[222:223], v91 offset:2368
    ds_read_b64_tr_b16 v[224:225], v90 offset:4224
    ds_read_b64_tr_b16 v[226:227], v90 offset:4480
    ds_read_b64_tr_b16 v[228:229], v91 offset:4224
    ds_read_b64_tr_b16 v[230:231], v91 offset:4480
    ds_read_b128 v[112:115], v108 offset:0
    ds_read_b128 v[116:119], v109 offset:0
    ds_read_b128 v[120:123], v110 offset:0
    s_waitcnt lgkmcnt(13)
    v_mfma_f32_16x16x32_bf16 v[144:147], v[208:211], v[16:19], 0
    ds_read_b64_tr_b16 v[232:233], v90 offset:6336
    ds_read_b64_tr_b16 v[234:235], v90 offset:6592
    s_waitcnt lgkmcnt(13)
    v_mfma_f32_16x16x32_bf16 v[148:151], v[212:215], v[16:19], 0
    ds_read_b64_tr_b16 v[236:237], v91 offset:6336
    ds_read_b64_tr_b16 v[238:239], v91 offset:6592
    v_mfma_f32_16x16x32_bf16 v[152:155], v[208:211], v[20:23], 0
    ds_read_b128 v[124:127], v111 offset:0
    ds_read_b128 v[128:131], v108 offset:64
    v_mfma_f32_16x16x32_bf16 v[156:159], v[212:215], v[20:23], 0
    ds_read_b128 v[132:135], v109 offset:64
    ds_read_b128 v[136:139], v110 offset:64
    s_waitcnt lgkmcnt(15)
    v_mfma_f32_16x16x32_bf16 v[160:163], v[216:219], v[16:19], 0
    ds_read_b128 v[140:143], v111 offset:64
    ds_read_u16 v98, v98
    v_mfma_f32_16x16x32_bf16 v[164:167], v[220:223], v[16:19], 0
    v_mfma_f32_16x16x32_bf16 v[168:171], v[216:219], v[20:23], 0
    v_mfma_f32_16x16x32_bf16 v[172:175], v[220:223], v[20:23], 0
    s_waitcnt lgkmcnt(15)
    v_mfma_f32_16x16x32_bf16 v[176:179], v[224:227], v[16:19], 0
    s_waitcnt lgkmcnt(13)
    v_mfma_f32_16x16x32_bf16 v[180:183], v[228:231], v[16:19], 0
    v_mfma_f32_16x16x32_bf16 v[184:187], v[224:227], v[20:23], 0
    v_mfma_f32_16x16x32_bf16 v[188:191], v[228:231], v[20:23], 0
    s_waitcnt lgkmcnt(8)
    v_mfma_f32_16x16x32_bf16 v[192:195], v[232:235], v[16:19], 0
    s_waitcnt lgkmcnt(6)
    v_mfma_f32_16x16x32_bf16 v[196:199], v[236:239], v[16:19], 0
    v_mfma_f32_16x16x32_bf16 v[200:203], v[232:235], v[20:23], 0
    v_mfma_f32_16x16x32_bf16 v[204:207], v[236:239], v[20:23], 0
    v_mfma_f32_16x16x32_bf16 v[84:87], v[76:79], v[112:115], 0
    v_pk_mul_f32 v[208:209], v[144:145], v[24:25]
    v_pk_mul_f32 v[210:211], v[146:147], v[26:27]
    v_pk_mul_f32 v[212:213], v[148:149], v[28:29]
    v_mfma_f32_16x16x32_bf16 v[80:83], v[112:115], v[112:115], 0
    v_pk_mul_f32 v[214:215], v[150:151], v[30:31]
    v_fmac_f32_dpp v208, v144, v40 row_ror:8 row_mask:0xf bank_mask:0xf
    v_fmac_f32_dpp v209, v145, v41 row_ror:8 row_mask:0xf bank_mask:0xf
    v_mfma_f32_16x16x32_bf16 v[84:87], v[76:79], v[116:119], v[84:87]
    v_fmac_f32_dpp v210, v146, v42 row_ror:8 row_mask:0xf bank_mask:0xf
    v_fmac_f32_dpp v211, v147, v43 row_ror:8 row_mask:0xf bank_mask:0xf
    v_fmac_f32_dpp v212, v148, v44 row_ror:8 row_mask:0xf bank_mask:0xf
    v_mfma_f32_16x16x32_bf16 v[80:83], v[116:119], v[116:119], v[80:83]
    v_fmac_f32_dpp v213, v149, v45 row_ror:8 row_mask:0xf bank_mask:0xf
    v_fmac_f32_dpp v214, v150, v46 row_ror:8 row_mask:0xf bank_mask:0xf
    v_fmac_f32_dpp v215, v151, v47 row_ror:8 row_mask:0xf bank_mask:0xf
    v_mfma_f32_16x16x32_bf16 v[84:87], v[76:79], v[120:123], v[84:87]
    v_cvt_pk_bf16_f32 v216, v208, v209
    v_cvt_pk_bf16_f32 v217, v210, v211
    v_cvt_pk_bf16_f32 v218, v212, v213
    v_mfma_f32_16x16x32_bf16 v[80:83], v[120:123], v[120:123], v[80:83]
    v_cvt_pk_bf16_f32 v219, v214, v215
    s_nop 1
    v_mfma_f32_16x16x32_bf16 v[224:227], v[56:59], v[216:219], 0
    v_xor_b32_dpp v220, v216, v72 row_ror:8 row_mask:0xf bank_mask:0xf
    s_waitcnt lgkmcnt(5)
    v_mfma_f32_16x16x32_bf16 v[84:87], v[76:79], v[124:127], v[84:87]
    v_xor_b32_dpp v221, v217, v72 row_ror:8 row_mask:0xf bank_mask:0xf
    v_xor_b32_dpp v222, v218, v72 row_ror:8 row_mask:0xf bank_mask:0xf
    v_xor_b32_dpp v223, v219, v72 row_ror:8 row_mask:0xf bank_mask:0xf
    v_mfma_f32_16x16x32_bf16 v[80:83], v[124:127], v[124:127], v[80:83]
    v_pk_mul_f32 v[208:209], v[160:161], v[24:25]
    v_pk_mul_f32 v[210:211], v[162:163], v[26:27]
    v_pk_mul_f32 v[212:213], v[164:165], v[28:29]
    s_waitcnt lgkmcnt(4)
    v_mfma_f32_16x16x32_bf16 v[84:87], v[76:79], v[128:131], v[84:87]
    v_pk_mul_f32 v[214:215], v[166:167], v[30:31]
    v_fmac_f32_dpp v208, v160, v40 row_ror:8 row_mask:0xf bank_mask:0xf
    v_fmac_f32_dpp v209, v161, v41 row_ror:8 row_mask:0xf bank_mask:0xf
    v_mfma_f32_16x16x32_bf16 v[80:83], v[128:131], v[128:131], v[80:83]
    v_mfma_f32_16x16x32_bf16 v[224:227], v[60:63], v[220:223], v[224:227]
    v_fmac_f32_dpp v210, v162, v42 row_ror:8 row_mask:0xf bank_mask:0xf
    v_fmac_f32_dpp v211, v163, v43 row_ror:8 row_mask:0xf bank_mask:0xf
    s_waitcnt lgkmcnt(3)
    v_mfma_f32_16x16x32_bf16 v[84:87], v[76:79], v[132:135], v[84:87]
    v_fmac_f32_dpp v212, v164, v44 row_ror:8 row_mask:0xf bank_mask:0xf
    v_fmac_f32_dpp v213, v165, v45 row_ror:8 row_mask:0xf bank_mask:0xf
    v_fmac_f32_dpp v214, v166, v46 row_ror:8 row_mask:0xf bank_mask:0xf
    v_mfma_f32_16x16x32_bf16 v[80:83], v[132:135], v[132:135], v[80:83]
    v_fmac_f32_dpp v215, v167, v47 row_ror:8 row_mask:0xf bank_mask:0xf
    v_cvt_pk_bf16_f32 v216, v208, v209
    v_cvt_pk_bf16_f32 v217, v210, v211
    s_waitcnt lgkmcnt(2)
    v_mfma_f32_16x16x32_bf16 v[84:87], v[76:79], v[136:139], v[84:87]
    v_cvt_pk_bf16_f32 v218, v212, v213
    v_cvt_pk_bf16_f32 v219, v214, v215
    s_nop 1
    v_mfma_f32_16x16x32_bf16 v[228:231], v[56:59], v[216:219], 0
    v_mfma_f32_16x16x32_bf16 v[80:83], v[136:139], v[136:139], v[80:83]
    v_xor_b32_dpp v220, v216, v72 row_ror:8 row_mask:0xf bank_mask:0xf
    v_xor_b32_dpp v221, v217, v72 row_ror:8 row_mask:0xf bank_mask:0xf
    v_xor_b32_dpp v222, v218, v72 row_ror:8 row_mask:0xf bank_mask:0xf
    s_waitcnt lgkmcnt(1)
    v_mfma_f32_16x16x32_bf16 v[84:87], v[76:79], v[140:143], v[84:87]
    v_xor_b32_dpp v223, v219, v72 row_ror:8 row_mask:0xf bank_mask:0xf
    v_pk_mul_f32 v[208:209], v[176:177], v[24:25]
    v_pk_mul_f32 v[210:211], v[178:179], v[26:27]
    v_mfma_f32_16x16x32_bf16 v[80:83], v[140:143], v[140:143], v[80:83]
    v_pk_mul_f32 v[212:213], v[180:181], v[28:29]
    v_pk_mul_f32 v[214:215], v[182:183], v[30:31]
    v_fmac_f32_dpp v208, v176, v40 row_ror:8 row_mask:0xf bank_mask:0xf
    v_fmac_f32_dpp v209, v177, v41 row_ror:8 row_mask:0xf bank_mask:0xf
    v_mfma_f32_16x16x32_bf16 v[228:231], v[60:63], v[220:223], v[228:231]
    v_fmac_f32_dpp v210, v178, v42 row_ror:8 row_mask:0xf bank_mask:0xf
    v_fmac_f32_dpp v211, v179, v43 row_ror:8 row_mask:0xf bank_mask:0xf
    v_fmac_f32_dpp v212, v180, v44 row_ror:8 row_mask:0xf bank_mask:0xf
    v_fmac_f32_dpp v213, v181, v45 row_ror:8 row_mask:0xf bank_mask:0xf
    v_fmac_f32_dpp v214, v182, v46 row_ror:8 row_mask:0xf bank_mask:0xf
    v_add_f32_dpp v11, v84, v84 quad_perm:[1,0,3,2] row_mask:0xf bank_mask:0xf
    v_fmac_f32_dpp v215, v183, v47 row_ror:8 row_mask:0xf bank_mask:0xf
    v_cndmask_b32 v10, v80, v81, s[46:47]
    v_cvt_pk_bf16_f32 v216, v208, v209
    s_waitcnt lgkmcnt(0)
    v_lshlrev_b32 v98, 16, v98
    v_cvt_pk_bf16_f32 v217, v210, v211
    v_add_f32_dpp v11, v11, v11 quad_perm:[2,3,0,1] row_mask:0xf bank_mask:0xf
    v_cvt_pk_bf16_f32 v218, v212, v213
    v_cndmask_b32 v10, v10, v82, s[48:49]
    v_cvt_pk_bf16_f32 v219, v214, v215
    v_mul_f32 v15, 0x3a800000, v11
    s_nop 0
    v_mfma_f32_16x16x32_bf16 v[232:235], v[56:59], v[216:219], 0
    v_cndmask_b32 v10, v10, v83, s[50:51]
    v_xor_b32_dpp v220, v216, v72 row_ror:8 row_mask:0xf bank_mask:0xf
    v_readlane_b32 s56, v15, 0
    v_xor_b32_dpp v221, v217, v72 row_ror:8 row_mask:0xf bank_mask:0xf
    v_readlane_b32 s57, v15, 4
    v_xor_b32_dpp v222, v218, v72 row_ror:8 row_mask:0xf bank_mask:0xf
    v_readlane_b32 s58, v15, 8
    v_xor_b32_dpp v223, v219, v72 row_ror:8 row_mask:0xf bank_mask:0xf
    v_readlane_b32 s59, v15, 12
    v_pk_mul_f32 v[208:209], v[192:193], v[24:25]
    v_pk_mul_f32 v[210:211], v[194:195], v[26:27]
    v_pk_mul_f32 v[212:213], v[196:197], v[28:29]
    v_pk_mul_f32 v[214:215], v[198:199], v[30:31]
    v_fmac_f32_dpp v208, v192, v40 row_ror:8 row_mask:0xf bank_mask:0xf
    v_fmac_f32_dpp v209, v193, v41 row_ror:8 row_mask:0xf bank_mask:0xf
    v_mfma_f32_16x16x32_bf16 v[232:235], v[60:63], v[220:223], v[232:235]
    v_fmac_f32_dpp v210, v194, v42 row_ror:8 row_mask:0xf bank_mask:0xf
    v_fmac_f32_dpp v211, v195, v43 row_ror:8 row_mask:0xf bank_mask:0xf
    v_fmac_f32_dpp v212, v196, v44 row_ror:8 row_mask:0xf bank_mask:0xf
    v_fmac_f32_dpp v213, v197, v45 row_ror:8 row_mask:0xf bank_mask:0xf
    v_fmac_f32_dpp v214, v198, v46 row_ror:8 row_mask:0xf bank_mask:0xf
    v_fmac_f32_dpp v215, v199, v47 row_ror:8 row_mask:0xf bank_mask:0xf
    v_cvt_pk_bf16_f32 v216, v208, v209
    v_cvt_pk_bf16_f32 v217, v210, v211
    v_cvt_pk_bf16_f32 v218, v212, v213
    v_cvt_pk_bf16_f32 v219, v214, v215
    s_nop 1
    v_mfma_f32_16x16x32_bf16 v[236:239], v[56:59], v[216:219], 0
    v_xor_b32_dpp v220, v216, v72 row_ror:8 row_mask:0xf bank_mask:0xf
    v_xor_b32_dpp v221, v217, v72 row_ror:8 row_mask:0xf bank_mask:0xf
    v_xor_b32_dpp v222, v218, v72 row_ror:8 row_mask:0xf bank_mask:0xf
    v_xor_b32_dpp v223, v219, v72 row_ror:8 row_mask:0xf bank_mask:0xf
    s_nop 1
    v_mfma_f32_16x16x32_bf16 v[236:239], v[60:63], v[220:223], v[236:239]
    v_mul_f32 v8, s56, v73
    v_add_f32_dpp v10, v10, v10 quad_perm:[1,0,3,2] row_mask:0xf bank_mask:0xf
    v_mov_b32 v9, v8
    s_nop 0
    v_add_f32_dpp v10, v10, v10 quad_perm:[2,3,0,1] row_mask:0xf bank_mask:0xf
    v_pk_add_f32 v[152:153], v[152:153], v[8:9]
    s_mov_b32 s45, 0x3a800000
    v_pk_add_f32 v[154:155], v[154:155], v[8:9]
    v_mul_f32 v12, s45, v11
    v_pk_add_f32 v[156:157], v[156:157], v[8:9]
    v_mul_f32 v14, s45, v10
    v_pk_add_f32 v[158:159], v[158:159], v[8:9]
    v_fma_f32 v14, -v12, v12, v14
    v_pk_mul_f32 v[112:113], v[152:153], v[32:33]
    v_max_f32 v14, 0, v14
    v_pk_mul_f32 v[114:115], v[154:155], v[34:35]
    v_cvt_pk_bf16_f32 v14, v14, v12
    v_pk_mul_f32 v[116:117], v[156:157], v[36:37]
    v_and_b32 v12, 0xffff0000, v14
    v_pk_mul_f32 v[118:119], v[158:159], v[38:39]
    v_lshlrev_b32 v14, 16, v14
    v_fmac_f32_dpp v112, v152, v48 row_ror:8 row_mask:0xf bank_mask:0xf
    v_add_f32 v14, 0x3727c5ac, v14
    v_fmac_f32_dpp v113, v153, v49 row_ror:8 row_mask:0xf bank_mask:0xf
    v_cvt_pk_bf16_f32 v14, v14, v14
    v_fmac_f32_dpp v114, v154, v50 row_ror:8 row_mask:0xf bank_mask:0xf
    v_lshlrev_b32 v14, 16, v14
    v_fmac_f32_dpp v115, v155, v51 row_ror:8 row_mask:0xf bank_mask:0xf
    v_sqrt_f32 v14, v14
    v_fmac_f32_dpp v116, v156, v52 row_ror:8 row_mask:0xf bank_mask:0xf
    v_cvt_pk_bf16_f32 v14, v14, v14
    v_fmac_f32_dpp v117, v157, v53 row_ror:8 row_mask:0xf bank_mask:0xf
    v_lshlrev_b32 v13, 16, v14
    v_fmac_f32_dpp v118, v158, v54 row_ror:8 row_mask:0xf bank_mask:0xf
    v_rcp_f32 v13, v13
    v_fmac_f32_dpp v119, v159, v55 row_ror:8 row_mask:0xf bank_mask:0xf
    v_sub_f32 v98, v98, v12
    v_cvt_pk_bf16_f32 v128, v112, v113
    v_sub_f32 v14, v15, v12
    v_cvt_pk_bf16_f32 v129, v114, v115
    v_mul_f32 v14, 0x44800000, v14
    v_cvt_pk_bf16_f32 v130, v116, v117
    v_cvt_pk_bf16_f32 v98, v98, v14
    v_cvt_pk_bf16_f32 v131, v118, v119
    v_lshlrev_b32 v12, 9, v3
    s_nop 0
    v_mfma_f32_16x16x32_bf16 v[240:243], v[56:59], v[128:131], 0
    v_lshlrev_b32 v10, 2, v3
    v_xor_b32_dpp v132, v128, v72 row_ror:8 row_mask:0xf bank_mask:0xf
    s_lshl_b32 s15, s12, 4
    v_xor_b32_dpp v133, v129, v72 row_ror:8 row_mask:0xf bank_mask:0xf
    s_add_u32 s15, s15, 54784
    v_xor_b32_dpp v134, v130, v72 row_ror:8 row_mask:0xf bank_mask:0xf
    v_add_u32 v10, s15, v10
    v_xor_b32_dpp v135, v131, v72 row_ror:8 row_mask:0xf bank_mask:0xf
    v_mul_f32 v8, s57, v73
    v_mov_b32 v9, v8
    v_mfma_f32_16x16x32_bf16 v[240:243], v[60:63], v[132:135], v[240:243]
    v_pk_add_f32 v[168:169], v[168:169], v[8:9]
    v_pk_add_f32 v[170:171], v[170:171], v[8:9]
    v_pk_add_f32 v[172:173], v[172:173], v[8:9]
    v_pk_add_f32 v[174:175], v[174:175], v[8:9]
    v_pk_mul_f32 v[112:113], v[168:169], v[32:33]
    v_pk_mul_f32 v[114:115], v[170:171], v[34:35]
    v_pk_mul_f32 v[116:117], v[172:173], v[36:37]
    v_pk_mul_f32 v[118:119], v[174:175], v[38:39]
    v_fmac_f32_dpp v112, v168, v48 row_ror:8 row_mask:0xf bank_mask:0xf
    v_fmac_f32_dpp v113, v169, v49 row_ror:8 row_mask:0xf bank_mask:0xf
    v_fmac_f32_dpp v114, v170, v50 row_ror:8 row_mask:0xf bank_mask:0xf
    v_fmac_f32_dpp v115, v171, v51 row_ror:8 row_mask:0xf bank_mask:0xf
    v_fmac_f32_dpp v116, v172, v52 row_ror:8 row_mask:0xf bank_mask:0xf
    v_fmac_f32_dpp v117, v173, v53 row_ror:8 row_mask:0xf bank_mask:0xf
    v_fmac_f32_dpp v118, v174, v54 row_ror:8 row_mask:0xf bank_mask:0xf
    v_fmac_f32_dpp v119, v175, v55 row_ror:8 row_mask:0xf bank_mask:0xf
    v_cvt_pk_bf16_f32 v224, v224, v240
    v_cvt_pk_bf16_f32 v225, v225, v241
    v_cvt_pk_bf16_f32 v226, v226, v242
    v_cvt_pk_bf16_f32 v227, v227, v243
    ds_write_b128 v92, v[224:227] offset:0
    v_cvt_pk_bf16_f32 v136, v112, v113
    s_mov_b64 exec, s[52:53]
    ds_write_b32 v10, v13
    buffer_store_dword v15, v12, s[32:35], s63 offen
    s_mov_b64 exec, -1
    v_cvt_pk_bf16_f32 v137, v114, v115
    v_mov_b32 v11, 0
    v_cvt_pk_bf16_f32 v138, v116, v117
    s_mov_b32 vcc_lo, 0x55555555
    v_cvt_pk_bf16_f32 v139, v118, v119
    s_mov_b32 vcc_hi, 0x55555555
    s_nop 0
    v_mfma_f32_16x16x32_bf16 v[244:247], v[56:59], v[136:139], 0
    v_cndmask_b32 v10, 0, v98, vcc
    v_xor_b32_dpp v140, v136, v72 row_ror:8 row_mask:0xf bank_mask:0xf
    ds_write_b64 v99, v[10:11] offset:64
    v_xor_b32_dpp v141, v137, v72 row_ror:8 row_mask:0xf bank_mask:0xf
    v_xor_b32_dpp v142, v138, v72 row_ror:8 row_mask:0xf bank_mask:0xf
    v_xor_b32_dpp v143, v139, v72 row_ror:8 row_mask:0xf bank_mask:0xf
    v_mul_f32 v8, s58, v73
    v_mov_b32 v9, v8
    v_mfma_f32_16x16x32_bf16 v[244:247], v[60:63], v[140:143], v[244:247]
    v_pk_add_f32 v[184:185], v[184:185], v[8:9]
    v_pk_add_f32 v[186:187], v[186:187], v[8:9]
    v_pk_add_f32 v[188:189], v[188:189], v[8:9]
    v_pk_add_f32 v[190:191], v[190:191], v[8:9]
    v_pk_mul_f32 v[112:113], v[184:185], v[32:33]
    v_pk_mul_f32 v[114:115], v[186:187], v[34:35]
    v_pk_mul_f32 v[116:117], v[188:189], v[36:37]
    v_pk_mul_f32 v[118:119], v[190:191], v[38:39]
    v_fmac_f32_dpp v112, v184, v48 row_ror:8 row_mask:0xf bank_mask:0xf
    v_fmac_f32_dpp v113, v185, v49 row_ror:8 row_mask:0xf bank_mask:0xf
    v_fmac_f32_dpp v114, v186, v50 row_ror:8 row_mask:0xf bank_mask:0xf
    v_fmac_f32_dpp v115, v187, v51 row_ror:8 row_mask:0xf bank_mask:0xf
    v_fmac_f32_dpp v116, v188, v52 row_ror:8 row_mask:0xf bank_mask:0xf
    v_fmac_f32_dpp v117, v189, v53 row_ror:8 row_mask:0xf bank_mask:0xf
    v_fmac_f32_dpp v118, v190, v54 row_ror:8 row_mask:0xf bank_mask:0xf
    v_fmac_f32_dpp v119, v191, v55 row_ror:8 row_mask:0xf bank_mask:0xf
    v_cvt_pk_bf16_f32 v228, v228, v244
    v_cvt_pk_bf16_f32 v229, v229, v245
    v_cvt_pk_bf16_f32 v230, v230, v246
    v_cvt_pk_bf16_f32 v231, v231, v247
    ds_write_b128 v92, v[228:231] offset:1312
    v_cvt_pk_bf16_f32 v128, v112, v113
    v_cvt_pk_bf16_f32 v129, v114, v115
    v_cvt_pk_bf16_f32 v130, v116, v117
    v_cvt_pk_bf16_f32 v131, v118, v119
    s_nop 1
    v_mfma_f32_16x16x32_bf16 v[248:251], v[56:59], v[128:131], 0
    v_xor_b32_dpp v132, v128, v72 row_ror:8 row_mask:0xf bank_mask:0xf
    v_xor_b32_dpp v133, v129, v72 row_ror:8 row_mask:0xf bank_mask:0xf
    v_xor_b32_dpp v134, v130, v72 row_ror:8 row_mask:0xf bank_mask:0xf
    v_xor_b32_dpp v135, v131, v72 row_ror:8 row_mask:0xf bank_mask:0xf
    v_mul_f32 v8, s59, v73
    v_mov_b32 v9, v8
    v_mfma_f32_16x16x32_bf16 v[248:251], v[60:63], v[132:135], v[248:251]
    v_pk_add_f32 v[200:201], v[200:201], v[8:9]
    v_pk_add_f32 v[202:203], v[202:203], v[8:9]
    v_pk_add_f32 v[204:205], v[204:205], v[8:9]
    v_pk_add_f32 v[206:207], v[206:207], v[8:9]
    v_pk_mul_f32 v[112:113], v[200:201], v[32:33]
    v_pk_mul_f32 v[114:115], v[202:203], v[34:35]
    v_pk_mul_f32 v[116:117], v[204:205], v[36:37]
    v_pk_mul_f32 v[118:119], v[206:207], v[38:39]
    v_fmac_f32_dpp v112, v200, v48 row_ror:8 row_mask:0xf bank_mask:0xf
    v_fmac_f32_dpp v113, v201, v49 row_ror:8 row_mask:0xf bank_mask:0xf
    v_fmac_f32_dpp v114, v202, v50 row_ror:8 row_mask:0xf bank_mask:0xf
    v_fmac_f32_dpp v115, v203, v51 row_ror:8 row_mask:0xf bank_mask:0xf
    v_fmac_f32_dpp v116, v204, v52 row_ror:8 row_mask:0xf bank_mask:0xf
    v_fmac_f32_dpp v117, v205, v53 row_ror:8 row_mask:0xf bank_mask:0xf
    v_fmac_f32_dpp v118, v206, v54 row_ror:8 row_mask:0xf bank_mask:0xf
    v_fmac_f32_dpp v119, v207, v55 row_ror:8 row_mask:0xf bank_mask:0xf
    v_cvt_pk_bf16_f32 v232, v232, v248
    v_cvt_pk_bf16_f32 v233, v233, v249
    v_cvt_pk_bf16_f32 v234, v234, v250
    v_cvt_pk_bf16_f32 v235, v235, v251
    ds_write_b128 v92, v[232:235] offset:2624
    v_cvt_pk_bf16_f32 v136, v112, v113
    v_cvt_pk_bf16_f32 v137, v114, v115
    v_cvt_pk_bf16_f32 v138, v116, v117
    v_cvt_pk_bf16_f32 v139, v118, v119
    s_nop 1
    v_mfma_f32_16x16x32_bf16 v[252:255], v[56:59], v[136:139], 0
    v_xor_b32_dpp v140, v136, v72 row_ror:8 row_mask:0xf bank_mask:0xf
    v_xor_b32_dpp v141, v137, v72 row_ror:8 row_mask:0xf bank_mask:0xf
    v_xor_b32_dpp v142, v138, v72 row_ror:8 row_mask:0xf bank_mask:0xf
    v_xor_b32_dpp v143, v139, v72 row_ror:8 row_mask:0xf bank_mask:0xf
    s_nop 1
    v_mfma_f32_16x16x32_bf16 v[252:255], v[60:63], v[140:143], v[252:255]
    v_lshlrev_b32 v10, 4, v3
    v_add_u32 v10, 54784, v10
    s_nop 5
    v_cvt_pk_bf16_f32 v236, v236, v252
    v_cvt_pk_bf16_f32 v237, v237, v253
    v_cvt_pk_bf16_f32 v238, v238, v254
    v_cvt_pk_bf16_f32 v239, v239, v255
    ds_write_b128 v92, v[236:239] offset:3936
    s_waitcnt lgkmcnt(0)
    s_barrier
    ds_read_b128 v[112:115], v10
    ds_read_b64_tr_b16 v[144:145], v93 offset:0
    ds_read_b64_tr_b16 v[146:147], v93 offset:640
    ds_read_b64_tr_b16 v[148:149], v93 offset:80
    ds_read_b64_tr_b16 v[150:151], v93 offset:720
    ds_read_b64_tr_b16 v[152:153], v93 offset:160
    ds_read_b64_tr_b16 v[154:155], v93 offset:800
    ds_read_b64_tr_b16 v[156:157], v93 offset:240
    ds_read_b64_tr_b16 v[158:159], v93 offset:880
    ds_read_b64_tr_b16 v[160:161], v93 offset:320
    ds_read_b64_tr_b16 v[162:163], v93 offset:960
    ds_read_b64_tr_b16 v[164:165], v93 offset:400
    ds_read_b64_tr_b16 v[166:167], v93 offset:1040
    ds_read_b64_tr_b16 v[168:169], v93 offset:480
    ds_read_b64_tr_b16 v[170:171], v93 offset:1120
    s_waitcnt lgkmcnt(14)
    ds_read_b64_tr_b16 v[172:173], v93 offset:560
    ds_read_b64_tr_b16 v[174:175], v93 offset:1200
    ds_read_b64_tr_b16 v[176:177], v97 offset:0
    ds_read_b64_tr_b16 v[178:179], v97 offset:640
    v_pk_mul_f32 v[64:65], v[64:65], v[112:113]
    v_pk_mul_f32 v[68:69], v[68:69], v[112:113]
    v_pk_mul_f32 v[66:67], v[66:67], v[114:115]
    v_pk_mul_f32 v[70:71], v[70:71], v[114:115]
    v_cvt_pk_bf16_f32 v116, v64, v65
    v_cvt_pk_bf16_f32 v117, v66, v67
    v_cvt_pk_bf16_f32 v118, v68, v69
    v_cvt_pk_bf16_f32 v119, v70, v71
    s_waitcnt lgkmcnt(14)
    s_nop 0
    v_mfma_f32_16x16x32_bf16 v[180:183], v[116:119], v[144:147], 0
    v_mfma_f32_16x16x32_bf16 v[184:187], v[116:119], v[148:151], 0
    s_waitcnt lgkmcnt(10)
    v_mfma_f32_16x16x32_bf16 v[188:191], v[116:119], v[152:155], 0
    v_mfma_f32_16x16x32_bf16 v[192:195], v[116:119], v[156:159], 0
    s_waitcnt lgkmcnt(6)
    v_mfma_f32_16x16x32_bf16 v[196:199], v[116:119], v[160:163], 0
    v_mfma_f32_16x16x32_bf16 v[200:203], v[116:119], v[164:167], 0
    s_waitcnt lgkmcnt(2)
    v_mfma_f32_16x16x32_bf16 v[204:207], v[116:119], v[168:171], 0
    v_mfma_f32_16x16x32_bf16 v[208:211], v[116:119], v[172:175], 0
    s_waitcnt lgkmcnt(0)
    v_mfma_f32_16x16x32_bf16 v[212:215], v[116:119], v[176:179], 0
    v_cvt_pk_bf16_f32 v128, v180, v184
    v_cvt_pk_bf16_f32 v129, v188, v192
    s_nop 0
    v_cvt_pk_bf16_f32 v130, v196, v200
    s_nop 1
    v_cvt_pk_bf16_f32 v131, v204, v208
    buffer_store_dwordx4 v[128:131], v94, s[28:31], s66 offen sc1
    s_add_u32 s66, s66, 0x40000
    v_cvt_pk_bf16_f32 v132, v181, v185
    v_cvt_pk_bf16_f32 v133, v189, v193
    v_cvt_pk_bf16_f32 v134, v197, v201
    v_cvt_pk_bf16_f32 v135, v205, v209
    buffer_store_dwordx4 v[132:135], v94, s[28:31], s66 offen sc1
    s_add_u32 s66, s66, 0x40000
    v_cvt_pk_bf16_f32 v136, v182, v186
    v_cvt_pk_bf16_f32 v137, v190, v194
    v_cvt_pk_bf16_f32 v138, v198, v202
    v_cvt_pk_bf16_f32 v139, v206, v210
    buffer_store_dwordx4 v[136:139], v94, s[28:31], s66 offen sc1
    s_add_u32 s66, s66, 0x40000
    v_cvt_pk_bf16_f32 v140, v183, v187
    v_cvt_pk_bf16_f32 v141, v191, v195
    v_cvt_pk_bf16_f32 v142, v199, v203
    v_cvt_pk_bf16_f32 v143, v207, v211
    buffer_store_dwordx4 v[140:143], v94, s[28:31], s66 offen sc1
    s_add_u32 s24, s4, 67108864
    s_addc_u32 s25, s5, 0
    s_mov_b32 s26, 7340032
    s_mov_b32 s27, 0x20000
    s_waitcnt vmcnt(5)
    buffer_store_dwordx4 v[100:103], v104, s[24:27], 0 offen sc1
    s_cmp_eq_u32 s11, 0
    s_cbranch_scc1 fa_kernel_c0
    buffer_store_short_d16_hi v131, v95, s[36:39], s67 offen
    s_add_u32 s67, s67, 4096
    buffer_store_short_d16_hi v135, v95, s[36:39], s67 offen
    s_add_u32 s67, s67, 4096
    buffer_store_short_d16_hi v139, v95, s[36:39], s67 offen
    s_add_u32 s67, s67, 4096
    buffer_store_short_d16_hi v143, v95, s[36:39], s67 offen
    s_branch fa_kernel_fin
fa_kernel_c0:
    v_cvt_pk_bf16_f32 v212, v212, v212
    buffer_store_short v212, v96, s[36:39], s67 offen
    s_add_u32 s67, s67, 4096
    v_cvt_pk_bf16_f32 v213, v213, v213
    buffer_store_short v213, v96, s[36:39], s67 offen
    s_add_u32 s67, s67, 4096
    v_cvt_pk_bf16_f32 v214, v214, v214
    buffer_store_short v214, v96, s[36:39], s67 offen
    s_add_u32 s67, s67, 4096
    v_cvt_pk_bf16_f32 v215, v215, v215
    buffer_store_short v215, v96, s[36:39], s67 offen
fa_kernel_fin:
fa_kernel_end:
    s_endpgm
.globl m_kernel
.p2align 8
.type m_kernel,@function
m_kernel:
    s_cmp_ge_u32 s2, 256
    s_cbranch_scc1 m_kernel_end
    s_load_dwordx2 s[4:5], s[0:1], 96
    s_load_dwordx2 s[6:7], s[0:1], 0
    v_lshrrev_b32 v2, 6, v0
    v_and_b32 v1, 63, v0
    v_readfirstlane_b32 s12, v2
    s_nop 0
    s_cmp_ge_u32 s12, 4
    s_cbranch_scc1 m_kernel_loader
    s_and_b32 s13, s2, 7
    s_lshr_b32 s14, s2, 3
    s_sub_u32 s15, 16, s13
    s_cmp_eq_u32 s13, 0
    s_cselect_b32 s15, 8, s15
    s_bitcmp1_b32 s14, 0
    s_cselect_b32 s10, s15, s13
    s_lshr_b32 s11, s14, 1
    s_sub_u32 s16, 16, s10
    s_and_b32 s16, s16, 15
    s_sub_u32 s17, 15, s11
    s_lshr_b32 s19, s11, 3
    s_cmp_lg_u32 s19, 0
    s_cselect_b32 s16, s16, s10
    s_cselect_b32 s17, s17, s11
    v_and_b32 v2, 15, v1
    v_lshrrev_b32 v3, 4, v1
    v_lshrrev_b32 v6, 3, v1
    v_and_b32 v7, 1, v3
    v_lshrrev_b32 v8, 1, v1
    v_and_b32 v8, 3, v8
    v_xor_b32 v7, v7, v8
    v_lshlrev_b32 v7, 5, v7
    v_lshl_add_u32 v4, v6, 10, v7
    v_and_b32 v7, 1, v1
    v_lshl_add_u32 v4, v7, 4, v4
    v_add_u32 v7, s17, v6
    v_and_b32 v7, 7, v7
    v_lshl_add_u32 v4, v7, 7, v4
    v_xor_b32 v5, 64, v4
    v_add_u32 v5, 7168, v5
    s_lshl_b32 s14, s16, 2
    s_add_u32 s14, s14, s12
    s_lshl_b32 s14, s14, 16
    s_lshl_b32 s18, s12, 13
    v_xor_b32 v8, v3, v1
    v_and_b32 v8, 7, v8
    v_lshlrev_b32 v8, 4, v8
    v_lshl_add_u32 v6, v6, 15, v8
    v_xor_b32 v7, 64, v6
    v_add_u32 v7, 261120, v7
    s_lshl_b32 s61, s12, 19
    s_lshl_b32 s15, s10, 11
    s_add_u32 s61, s61, s15
    s_lshl_b32 s15, s11, 7
    s_add_u32 s61, s61, s15
    s_lshl_b32 s62, s12, 12
    s_add_u32 s62, s62, 32768
    s_lshl_b32 s63, s10, 3
    s_add_u32 s63, s63, s11
    s_lshl_b32 s63, s63, 9
    s_sub_u32 s63, s63, 512
    s_cmp_eq_u32 s11, 0
    s_cselect_b32 s15, 65536, 0
    s_add_u32 s63, s63, s15
    s_cmp_lt_u32 s11, 8
    s_cselect_b32 s63, s63, 0x40000000
    s_lshl_b32 s15, s16, 12
    v_mov_b32 v9, s15
    v_mov_b32 v10, s63
    v_cmp_gt_u32 vcc, 32, v1
    s_nop 1
    v_cndmask_b32 v9, v10, v9, vcc
    v_lshl_add_u32 v9, v1, 4, v9
    v_lshlrev_b32 v10, 6, v2
    s_lshl_b32 s15, s12, 8
    s_add_u32 s15, s15, s10
    s_lshl_b32 s15, s15, 2
    s_waitcnt lgkmcnt(0)
    s_mov_b32 s20, s4
    s_mov_b32 s21, s5
    s_mov_b32 s22, 4194304
    s_mov_b32 s23, 0x20000
    s_add_u32 s28, s4, 4718592
    s_addc_u32 s29, s5, 0
    s_mov_b32 s30, 131072
    s_mov_b32 s31, 0x20000
    s_add_u32 m0, s18, 0
    s_nop 0
    buffer_load_dwordx4 v4, s[20:23], s14 offen lds
    buffer_load_dwordx4 v5, s[20:23], s14 offen offset:1024 lds
    s_add_u32 s14, s14, 16384
    s_add_u32 m0, s18, 2048
    s_nop 0
    buffer_load_dwordx4 v4, s[20:23], s14 offen lds
    buffer_load_dwordx4 v5, s[20:23], s14 offen offset:1024 lds
    s_add_u32 s14, s14, 16384
    s_add_u32 m0, s18, 4096
    s_nop 0
    buffer_load_dwordx4 v4, s[20:23], s14 offen lds
    buffer_load_dwordx4 v5, s[20:23], s14 offen offset:1024 lds
    s_add_u32 s14, s14, 16384
    s_add_u32 m0, s18, 6144
    s_nop 0
    buffer_load_dwordx4 v4, s[20:23], s14 offen lds
    buffer_load_dwordx4 v5, s[20:23], s14 offen offset:1024 lds
    s_mov_b32 m0, 135168
    s_mov_b32 s24, s6
    s_mov_b32 s25, s7
    s_mov_b32 s26, 4194304
    s_mov_b32 s27, 0x20000
    buffer_load_dwordx4 v9, s[28:31], 0 offen lds
    s_add_u32 s40, s4, 28573696
    s_addc_u32 s41, s5, 0
    s_mov_b32 s42, 8192
    s_mov_b32 s43, 0x20000
    s_add_u32 m0, s62, 0
    s_nop 0
    buffer_load_dwordx4 v6, s[24:27], s61 offen lds
    buffer_load_dwordx4 v7, s[24:27], s61 offen offset:1024 lds
    s_add_u32 m0, s62, 2048
    s_add_u32 s61, s61, 2097152
    buffer_load_dwordx4 v6, s[24:27], s61 offen lds
    buffer_load_dwordx4 v7, s[24:27], s61 offen offset:1024 lds
    s_add_u32 s14, s15, 4096
    buffer_load_dword v241, v10, s[40:43], s15 offen
    buffer_load_dword v242, v10, s[40:43], s14 offen
    s_lshl_b32 s15, s12, 4
    v_add_u32 v6, s15, v2
    s_cmp_lg_u32 s10, 0
    s_cselect_b32 s15, -1, 0
    v_sub_u32 v7, s15, v6
    s_cmp_lg_u32 s19, 0
    s_cselect_b64 vcc, -1, 0
    v_cndmask_b32 v6, v6, v7, vcc
    v_and_b32 v6, 127, v6
    v_cvt_f32_u32 v7, v6
    v_mul_f32 v7, 0x3c000000, v7
    v_lshlrev_b32 v10, 3, v3
    v_cvt_f32_u32 v10, v10
    v_mul_f32 v10, v10, v7
    v_cos_f32 v12, v10
    v_sin_f32 v14, v10
    v_add_f32 v10, v10, v7
    v_cos_f32 v13, v10
    v_sin_f32 v15, v10
    v_cvt_pk_bf16_f32 v112, v12, v13
    v_cvt_pk_bf16_f32 v128, v14, v15
    v_add_f32 v10, v10, v7
    v_cos_f32 v12, v10
    v_sin_f32 v14, v10
    v_add_f32 v10, v10, v7
    v_cos_f32 v13, v10
    v_sin_f32 v15, v10
    v_cvt_pk_bf16_f32 v113, v12, v13
    v_cvt_pk_bf16_f32 v129, v14, v15
    v_add_f32 v10, v10, v7
    v_cos_f32 v12, v10
    v_sin_f32 v14, v10
    v_add_f32 v10, v10, v7
    v_cos_f32 v13, v10
    v_sin_f32 v15, v10
    v_cvt_pk_bf16_f32 v114, v12, v13
    v_cvt_pk_bf16_f32 v130, v14, v15
    v_add_f32 v10, v10, v7
    v_cos_f32 v12, v10
    v_sin_f32 v14, v10
    v_add_f32 v10, v10, v7
    v_cos_f32 v13, v10
    v_sin_f32 v15, v10
    v_cvt_pk_bf16_f32 v115, v12, v13
    v_cvt_pk_bf16_f32 v131, v14, v15
    v_and_b32 v8, 1, v6
    v_cmp_eq_u32 vcc, 1, v8
    v_mul_u32_u24 v8, 0x8000, v8
    v_lshl_or_b32 v8, v8, 16, v8
    v_and_b32 v10, 2, v6
    v_mul_u32_u24 v10, 0x4000, v10
    v_lshl_or_b32 v10, v10, 16, v10
    v_xor_b32 v11, v10, v8
    v_cndmask_b32 v12, v112, v128, vcc
    v_cndmask_b32 v13, v128, v112, vcc
    v_xor_b32 v116, v11, v12
    v_xor_b32 v132, v10, v13
    v_cndmask_b32 v12, v113, v129, vcc
    v_cndmask_b32 v13, v129, v113, vcc
    v_xor_b32 v117, v11, v12
    v_xor_b32 v133, v10, v13
    v_cndmask_b32 v12, v114, v130, vcc
    v_cndmask_b32 v13, v130, v114, vcc
    v_xor_b32 v118, v11, v12
    v_xor_b32 v134, v10, v13
    v_cndmask_b32 v12, v115, v131, vcc
    v_cndmask_b32 v13, v131, v115, vcc
    v_xor_b32 v119, v11, v12
    v_xor_b32 v135, v10, v13
    v_xor_b32 v120, v8, v112
    v_xor_b32 v136, v8, v128
    v_xor_b32 v121, v8, v113
    v_xor_b32 v137, v8, v129
    v_xor_b32 v122, v8, v114
    v_xor_b32 v138, v8, v130
    v_xor_b32 v123, v8, v115
    v_xor_b32 v139, v8, v131
    v_xor_b32 v124, v8, v116
    v_xor_b32 v140, v8, v132
    v_xor_b32 v125, v8, v117
    v_xor_b32 v141, v8, v133
    v_xor_b32 v126, v8, v118
    v_xor_b32 v142, v8, v134
    v_xor_b32 v127, v8, v119
    v_xor_b32 v143, v8, v135
    s_brev_b32 s15, 1
    v_xor_b32 v144, s15, v112
    v_xor_b32 v145, s15, v113
    v_xor_b32 v146, s15, v114
    v_xor_b32 v147, s15, v115
    v_xor_b32 v148, s15, v116
    v_xor_b32 v149, s15, v117
    v_xor_b32 v150, s15, v118
    v_xor_b32 v151, s15, v119
    v_xor_b32 v152, s15, v120
    v_xor_b32 v153, s15, v121
    v_xor_b32 v154, s15, v122
    v_xor_b32 v155, s15, v123
    v_xor_b32 v156, s15, v124
    v_xor_b32 v157, s15, v125
    v_xor_b32 v158, s15, v126
    v_xor_b32 v159, s15, v127
    v_xor_b32 v160, s15, v128
    v_xor_b32 v161, s15, v129
    v_xor_b32 v162, s15, v130
    v_xor_b32 v163, s15, v131
    v_xor_b32 v164, s15, v132
    v_xor_b32 v165, s15, v133
    v_xor_b32 v166, s15, v134
    v_xor_b32 v167, s15, v135
    v_xor_b32 v168, s15, v136
    v_xor_b32 v169, s15, v137
    v_xor_b32 v170, s15, v138
    v_xor_b32 v171, s15, v139
    v_xor_b32 v172, s15, v140
    v_xor_b32 v173, s15, v141
    v_xor_b32 v174, s15, v142
    v_xor_b32 v175, s15, v143
    v_lshrrev_b32 v10, 2, v2
    v_lshl_add_u32 v10, v3, 3, v10
    v_lshrrev_b32 v11, 3, v2
    v_and_b32 v12, 1, v3
    v_lshl_add_u32 v11, v12, 1, v11
    v_lshlrev_b32 v11, 5, v11
    v_lshl_add_u32 v10, v10, 7, v11
    v_and_b32 v11, 3, v2
    v_lshl_add_u32 v216, v11, 3, v10
    s_mul_i32 s15, s19, 96
    v_xor_b32 v216, s15, v216
    v_xor_b32 v217, 64, v216
    v_xor_b32 v218, 32, v216
    v_xor_b32 v219, 96, v216
    v_and_b32 v11, 1, v2
    v_lshlrev_b32 v11, 9, v11
    v_lshl_add_u32 v11, v3, 4, v11
    v_add_u32 v244, 135168, v11
    s_mul_i32 s15, s19, 3
    v_xor_b32 v10, s15, v3
    v_lshrrev_b32 v11, 1, v10
    v_lshrrev_b32 v12, 1, v2
    v_xor_b32 v11, v11, v12
    v_lshlrev_b32 v11, 4, v11
    v_lshl_add_u32 v11, v2, 7, v11
    v_and_b32 v12, 1, v10
    v_lshl_add_u32 v11, v12, 3, v11
    v_add_u32 v220, s62, v11
    v_xor_b32 v221, 32, v220
    v_xor_b32 v222, 64, v220
    v_xor_b32 v223, 96, v220
    v_lshl_add_u32 v10, v10, 4, v2
    v_lshlrev_b32 v243, 4, v10
    v_add_u32 v10, 48, v1
    v_and_b32 v10, 63, v10
    v_lshlrev_b32 v240, 2, v10
    v_cmp_eq_u32 s[46:47], 0, v3
    s_add_u32 s52, s4, 75497472
    s_addc_u32 s53, s5, 0
    s_mov_b32 s54, 8388608
    s_mov_b32 s55, 0x20000
    v_cmp_lt_u32 vcc, 383, v243
    v_add_u32 v10, 128, v243
    s_nop 0
    v_cndmask_b32 v243, v243, v10, vcc
    s_cmp_eq_u32 s11, 0
    s_cselect_b32 s15, 8192, 0
    s_add_u32 s32, s4, 28835840
    s_addc_u32 s33, s5, 0
    s_mov_b32 s34, s15
    s_mov_b32 s35, 0x20000
    s_add_u32 s36, s4, 39845888
    s_addc_u32 s37, s5, 0
    s_mov_b32 s38, 262144
    s_mov_b32 s39, 0x20000
    s_lshl_b32 s13, s10, 3
    s_add_u32 s13, s13, s12
    s_waitcnt vmcnt(6)
    s_barrier
    ds_read_b64_tr_b16 v[16:17], v216 offset:0
    ds_read_b64_tr_b16 v[18:19], v216 offset:512
    ds_read_b64_tr_b16 v[20:21], v216 offset:4096
    ds_read_b64_tr_b16 v[22:23], v216 offset:4608
    ds_read_b64_tr_b16 v[24:25], v216 offset:8192
    ds_read_b64_tr_b16 v[26:27], v216 offset:8704
    ds_read_b64_tr_b16 v[28:29], v216 offset:12288
    ds_read_b64_tr_b16 v[30:31], v216 offset:12800
    ds_read_b128 v[80:83], v244 offset:0
    ds_read_b128 v[84:87], v244 offset:64
    ds_read_b128 v[88:91], v244 offset:128
    ds_read_b128 v[92:95], v244 offset:192
    ds_read_b128 v[96:99], v244 offset:256
    ds_read_b128 v[100:103], v244 offset:320
    ds_read_b128 v[104:107], v244 offset:384
    ds_read_b128 v[108:111], v244 offset:448
    s_waitcnt lgkmcnt(14)
    v_mfma_f32_16x16x32_bf16 v[176:179], v[16:19], v[112:115], 0
    ds_read_b64_tr_b16 v[32:33], v216 offset:16384
    ds_read_b64_tr_b16 v[34:35], v216 offset:16896
    v_mfma_f32_16x16x32_bf16 v[192:195], v[16:19], v[144:147], 0
    ds_read_b64_tr_b16 v[36:37], v216 offset:20480
    ds_read_b64_tr_b16 v[38:39], v216 offset:20992
    s_waitcnt lgkmcnt(15)
    v_mfma_f32_16x16x32_bf16 v[176:179], v[20:23], v[116:119], v[176:179]
    ds_read_b64_tr_b16 v[40:41], v216 offset:24576
    ds_read_b64_tr_b16 v[42:43], v216 offset:25088
    v_mfma_f32_16x16x32_bf16 v[192:195], v[20:23], v[148:151], v[192:195]
    ds_read_b64_tr_b16 v[44:45], v216 offset:28672
    ds_read_b64_tr_b16 v[46:47], v216 offset:29184
    s_waitcnt lgkmcnt(15)
    v_mfma_f32_16x16x32_bf16 v[176:179], v[24:27], v[120:123], v[176:179]
    v_mfma_f32_16x16x32_bf16 v[192:195], v[24:27], v[152:155], v[192:195]
    v_mfma_f32_16x16x32_bf16 v[176:179], v[28:31], v[124:127], v[176:179]
    v_mfma_f32_16x16x32_bf16 v[192:195], v[28:31], v[156:159], v[192:195]
    v_mfma_f32_16x16x32_bf16 v[208:211], v[80:83], v[112:115], 0
    ds_read_b64_tr_b16 v[48:49], v217 offset:0
    v_mfma_f32_16x16x32_bf16 v[212:215], v[80:83], v[144:147], 0
    ds_read_b64_tr_b16 v[50:51], v217 offset:512
    s_waitcnt lgkmcnt(15)
    v_mfma_f32_16x16x32_bf16 v[208:211], v[84:87], v[116:119], v[208:211]
    ds_read_b64_tr_b16 v[52:53], v217 offset:4096
    v_mfma_f32_16x16x32_bf16 v[212:215], v[84:87], v[148:151], v[212:215]
    ds_read_b64_tr_b16 v[54:55], v217 offset:4608
    v_mfma_f32_16x16x32_bf16 v[208:211], v[88:91], v[120:123], v[208:211]
    ds_read_b64_tr_b16 v[56:57], v217 offset:8192
    v_mfma_f32_16x16x32_bf16 v[212:215], v[88:91], v[152:155], v[212:215]
    ds_read_b64_tr_b16 v[58:59], v217 offset:8704
    s_waitcnt lgkmcnt(15)
    v_mfma_f32_16x16x32_bf16 v[208:211], v[92:95], v[124:127], v[208:211]
    ds_read_b64_tr_b16 v[60:61], v217 offset:12288
    v_mfma_f32_16x16x32_bf16 v[212:215], v[92:95], v[156:159], v[212:215]
    ds_read_b64_tr_b16 v[62:63], v217 offset:12800
    v_mfma_f32_16x16x32_bf16 v[208:211], v[96:99], v[128:131], v[208:211]
    v_mfma_f32_16x16x32_bf16 v[212:215], v[96:99], v[160:163], v[212:215]
    v_mfma_f32_16x16x32_bf16 v[208:211], v[100:103], v[132:135], v[208:211]
    v_mfma_f32_16x16x32_bf16 v[212:215], v[100:103], v[164:167], v[212:215]
    v_mfma_f32_16x16x32_bf16 v[208:211], v[104:107], v[136:139], v[208:211]
    v_mfma_f32_16x16x32_bf16 v[212:215], v[104:107], v[168:171], v[212:215]
    s_waitcnt lgkmcnt(15)
    v_mfma_f32_16x16x32_bf16 v[208:211], v[108:111], v[140:143], v[208:211]
    v_mfma_f32_16x16x32_bf16 v[212:215], v[108:111], v[172:175], v[212:215]
    s_waitcnt lgkmcnt(14)
    v_mfma_f32_16x16x32_bf16 v[176:179], v[32:35], v[128:131], v[176:179]
    ds_read_b64_tr_b16 v[64:65], v217 offset:16384
    ds_read_b64_tr_b16 v[66:67], v217 offset:16896
    ds_read_b64_tr_b16 v[68:69], v217 offset:20480
    v_mfma_f32_16x16x32_bf16 v[192:195], v[32:35], v[160:163], v[192:195]
    ds_read_b64_tr_b16 v[70:71], v217 offset:20992
    ds_read_b64_tr_b16 v[72:73], v217 offset:24576
    ds_read_b64_tr_b16 v[74:75], v217 offset:25088
    s_waitcnt lgkmcnt(15)
    v_mfma_f32_16x16x32_bf16 v[176:179], v[36:39], v[132:135], v[176:179]
    s_waitcnt vmcnt(0)
    v_add_f32 v208, v208, v241
    v_add_f32 v212, v212, v242
    v_mfma_f32_16x16x32_bf16 v[192:195], v[36:39], v[164:167], v[192:195]
    v_sub_f32 v80, 0, v208
    v_sub_f32 v81, 0, v208
    v_sub_f32 v82, 0, v208
    v_mfma_f32_16x16x32_bf16 v[176:179], v[40:43], v[136:139], v[176:179]
    v_sub_f32 v83, 0, v208
    v_sub_f32 v84, 0, v212
    v_sub_f32 v85, 0, v212
    v_mfma_f32_16x16x32_bf16 v[192:195], v[40:43], v[168:171], v[192:195]
    v_sub_f32 v86, 0, v212
    v_sub_f32 v87, 0, v212
    ds_read_b64_tr_b16 v[76:77], v217 offset:28672
    s_waitcnt lgkmcnt(15)
    v_mfma_f32_16x16x32_bf16 v[176:179], v[44:47], v[140:143], v[176:179]
    ds_read_b64_tr_b16 v[78:79], v217 offset:29184
    v_mfma_f32_16x16x32_bf16 v[192:195], v[44:47], v[172:175], v[192:195]
    s_waitcnt lgkmcnt(14)
    v_mfma_f32_16x16x32_bf16 v[180:183], v[48:51], v[112:115], v[80:83]
    ds_read_b64_tr_b16 v[16:17], v218 offset:0
    ds_read_b64_tr_b16 v[18:19], v218 offset:512
    ds_read_b64_tr_b16 v[20:21], v218 offset:4096
    v_mfma_f32_16x16x32_bf16 v[196:199], v[48:51], v[144:147], v[84:87]
    ds_read_b64_tr_b16 v[22:23], v218 offset:4608
    ds_read_b64_tr_b16 v[24:25], v218 offset:8192
    ds_read_b64_tr_b16 v[26:27], v218 offset:8704
    s_waitcnt lgkmcnt(15)
    v_mfma_f32_16x16x32_bf16 v[180:183], v[52:55], v[116:119], v[180:183]
    ds_read_b64_tr_b16 v[28:29], v218 offset:12288
    ds_read_b64_tr_b16 v[30:31], v218 offset:12800
    ds_read_b64 v[224:225], v220 offset:0
    v_mfma_f32_16x16x32_bf16 v[196:199], v[52:55], v[148:151], v[196:199]
    ds_read_b64 v[232:233], v220 offset:2048
    ds_read_b64 v[226:227], v221 offset:0
    ds_read_b64 v[234:235], v221 offset:2048
    v_mfma_f32_16x16x32_bf16 v[180:183], v[56:59], v[120:123], v[180:183]
    ds_read_b64 v[228:229], v222 offset:0
    ds_read_b64 v[236:237], v222 offset:2048
    ds_read_b64 v[230:231], v223 offset:0
    v_mfma_f32_16x16x32_bf16 v[196:199], v[56:59], v[152:155], v[196:199]
    ds_read_b64 v[238:239], v223 offset:2048
    v_mov_b32 v4, 0x3f803f80
    v_mov_b32 v5, 0
    s_waitcnt lgkmcnt(15)
    v_mfma_f32_16x16x32_bf16 v[180:183], v[60:63], v[124:127], v[180:183]
    v_mov_b32 v7, 0
    v_mov_b32 v6, 0
    v_mov_b32 v8, 0
    v_mfma_f32_16x16x32_bf16 v[196:199], v[60:63], v[156:159], v[196:199]
    v_lshlrev_b32 v9, 2, v2
    v_mfma_f32_16x16x32_bf16 v[180:183], v[64:67], v[128:131], v[180:183]
    ds_read_b64_tr_b16 v[32:33], v218 offset:16384
    ds_read_b64_tr_b16 v[34:35], v218 offset:16896
    ds_read_b64_tr_b16 v[36:37], v218 offset:20480
    v_mfma_f32_16x16x32_bf16 v[196:199], v[64:67], v[160:163], v[196:199]
    ds_read_b64_tr_b16 v[38:39], v218 offset:20992
    ds_read_b64_tr_b16 v[40:41], v218 offset:24576
    ds_read_b64_tr_b16 v[42:43], v218 offset:25088
    v_mfma_f32_16x16x32_bf16 v[180:183], v[68:71], v[132:135], v[180:183]
    ds_read_b64_tr_b16 v[44:45], v218 offset:28672
    ds_read_b64_tr_b16 v[46:47], v218 offset:29184
    s_lshl_b32 s60, s13, 6
    v_mfma_f32_16x16x32_bf16 v[196:199], v[68:71], v[164:167], v[196:199]
    s_lshl_b32 s14, s13, 16
    s_lshl_b32 s15, s11, 12
    s_add_u32 s14, s14, s15
    v_mfma_f32_16x16x32_bf16 v[180:183], v[72:75], v[136:139], v[180:183]
    s_add_u32 s15, s14, 0x40000
    s_mov_b32 s62, 0x3f80
    s_mov_b32 s63, 0x3f800000
    v_mfma_f32_16x16x32_bf16 v[196:199], v[72:75], v[168:171], v[196:199]
    v_sub_f32 v209, v209, v208
    v_sub_f32 v213, v213, v212
    v_sub_f32 v176, v176, v208
    v_mfma_f32_16x16x32_bf16 v[180:183], v[76:79], v[140:143], v[180:183]
    v_sub_f32 v177, v177, v208
    v_sub_f32 v178, v178, v208
    v_sub_f32 v179, v179, v208
    v_mfma_f32_16x16x32_bf16 v[196:199], v[76:79], v[172:175], v[196:199]
    v_sub_f32 v192, v192, v212
    v_sub_f32 v193, v193, v212
    v_sub_f32 v194, v194, v212
    v_sub_f32 v195, v195, v212
    s_cmp_lg_u32 s19, 0
    s_cbranch_scc1 m_kernel_up
    s_waitcnt lgkmcnt(15)
    v_mfma_f32_16x16x32_bf16 v[184:187], v[16:19], v[112:115], v[80:83]
    ds_bpermute_b32 v10, v240, v179
    ds_bpermute_b32 v13, v240, v195
    ds_read_b64_tr_b16 v[48:49], v219 offset:0
    v_mfma_f32_16x16x32_bf16 v[200:203], v[16:19], v[144:147], v[84:87]
    ds_read_b64_tr_b16 v[50:51], v219 offset:512
    ds_read_b64_tr_b16 v[52:53], v219 offset:4096
    ds_read_b64_tr_b16 v[54:55], v219 offset:4608
    v_mfma_f32_16x16x32_bf16 v[184:187], v[20:23], v[116:119], v[184:187]
    ds_bpermute_b32 v11, v240, v183
    ds_bpermute_b32 v14, v240, v199
    ds_read_b64_tr_b16 v[56:57], v219 offset:8192
    v_mfma_f32_16x16x32_bf16 v[200:203], v[20:23], v[148:151], v[200:203]
    ds_read_b64_tr_b16 v[58:59], v219 offset:8704
    ds_read_b64_tr_b16 v[60:61], v219 offset:12288
    ds_read_b64_tr_b16 v[62:63], v219 offset:12800
    v_mfma_f32_16x16x32_bf16 v[184:187], v[24:27], v[120:123], v[184:187]
    s_waitcnt lgkmcnt(11)
    v_cndmask_b32 v248, v10, v209, s[46:47]
    s_waitcnt lgkmcnt(10)
    v_cndmask_b32 v252, v13, v213, s[46:47]
    s_waitcnt lgkmcnt(5)
    v_cndmask_b32 v249, v11, v10, s[46:47]
    v_mfma_f32_16x16x32_bf16 v[200:203], v[24:27], v[152:155], v[200:203]
    s_waitcnt lgkmcnt(4)
    v_cndmask_b32 v253, v14, v13, s[46:47]
    v_lshlrev_b32 v88, 16, v224
    v_add_f32 v248, v248, v88
    v_mfma_f32_16x16x32_bf16 v[184:187], v[28:31], v[124:127], v[184:187]
    v_and_b32 v89, 0xffff0000, v224
    v_add_f32 v176, v176, v89
    v_lshlrev_b32 v90, 16, v225
    v_mfma_f32_16x16x32_bf16 v[200:203], v[28:31], v[156:159], v[200:203]
    v_add_f32 v177, v177, v90
    v_and_b32 v91, 0xffff0000, v225
    v_add_f32 v178, v178, v91
    v_mfma_f32_16x16x32_bf16 v[184:187], v[32:35], v[128:131], v[184:187]
    v_lshlrev_b32 v88, 16, v226
    v_add_f32 v249, v249, v88
    v_and_b32 v89, 0xffff0000, v226
    v_mfma_f32_16x16x32_bf16 v[200:203], v[32:35], v[160:163], v[200:203]
    v_add_f32 v180, v180, v89
    v_lshlrev_b32 v90, 16, v227
    v_add_f32 v181, v181, v90
    v_mfma_f32_16x16x32_bf16 v[184:187], v[36:39], v[132:135], v[184:187]
    v_and_b32 v91, 0xffff0000, v227
    v_add_f32 v182, v182, v91
    v_lshlrev_b32 v88, 16, v232
    v_mfma_f32_16x16x32_bf16 v[200:203], v[36:39], v[164:167], v[200:203]
    v_add_f32 v252, v252, v88
    v_and_b32 v89, 0xffff0000, v232
    v_add_f32 v192, v192, v89
    v_mfma_f32_16x16x32_bf16 v[184:187], v[40:43], v[136:139], v[184:187]
    v_lshlrev_b32 v90, 16, v233
    v_add_f32 v193, v193, v90
    v_and_b32 v91, 0xffff0000, v233
    v_mfma_f32_16x16x32_bf16 v[200:203], v[40:43], v[168:171], v[200:203]
    v_add_f32 v194, v194, v91
    v_lshlrev_b32 v88, 16, v234
    v_add_f32 v253, v253, v88
    v_mfma_f32_16x16x32_bf16 v[184:187], v[44:47], v[140:143], v[184:187]
    v_and_b32 v89, 0xffff0000, v234
    v_add_f32 v196, v196, v89
    v_lshlrev_b32 v90, 16, v235
    v_mfma_f32_16x16x32_bf16 v[200:203], v[44:47], v[172:175], v[200:203]
    v_add_f32 v197, v197, v90
    v_and_b32 v91, 0xffff0000, v235
    v_add_f32 v198, v198, v91
    v_mfma_f32_16x16x32_bf16 v[188:191], v[48:51], v[112:115], v[80:83]
    v_cvt_pk_bf16_f32 v96, v248, v176
    v_cvt_pk_bf16_f32 v97, v177, v178
    v_cvt_pk_bf16_f32 v98, v249, v180
    v_mfma_f32_16x16x32_bf16 v[204:207], v[48:51], v[144:147], v[84:87]
    v_cvt_pk_bf16_f32 v99, v181, v182
    buffer_store_dwordx4 v[96:99], v243, s[52:55], s14 offen offset:0 sc1
    v_cvt_pk_bf16_f32 v104, v252, v192
    v_mfma_f32_16x16x32_bf16 v[188:191], v[52:55], v[116:119], v[188:191]
    v_cvt_pk_bf16_f32 v105, v193, v194
    v_cvt_pk_bf16_f32 v106, v253, v196
    v_cvt_pk_bf16_f32 v107, v197, v198
    v_mfma_f32_16x16x32_bf16 v[204:207], v[52:55], v[148:151], v[204:207]
    buffer_store_dwordx4 v[104:107], v243, s[52:55], s15 offen offset:0 sc1
    ds_read_b64_tr_b16 v[64:65], v219 offset:16384
    ds_read_b64_tr_b16 v[66:67], v219 offset:16896
    s_waitcnt lgkmcnt(4)
    v_mfma_f32_16x16x32_bf16 v[188:191], v[56:59], v[120:123], v[188:191]
    ds_read_b64_tr_b16 v[68:69], v219 offset:20480
    ds_read_b64_tr_b16 v[70:71], v219 offset:20992
    ds_read_b64_tr_b16 v[72:73], v219 offset:24576
    v_mfma_f32_16x16x32_bf16 v[204:207], v[56:59], v[152:155], v[204:207]
    ds_read_b64_tr_b16 v[74:75], v219 offset:25088
    ds_read_b64_tr_b16 v[76:77], v219 offset:28672
    ds_read_b64_tr_b16 v[78:79], v219 offset:29184
    s_waitcnt lgkmcnt(8)
    v_mfma_f32_16x16x32_bf16 v[188:191], v[60:63], v[124:127], v[188:191]
    ds_bpermute_b32 v12, v240, v187
    ds_bpermute_b32 v15, v240, v203
    v_mfma_f32_16x16x32_bf16 v[204:207], v[60:63], v[156:159], v[204:207]
    s_waitcnt lgkmcnt(8)
    v_mfma_f32_16x16x32_bf16 v[188:191], v[64:67], v[128:131], v[188:191]
    s_waitcnt lgkmcnt(1)
    v_cndmask_b32 v250, v12, v11, s[46:47]
    s_waitcnt lgkmcnt(0)
    v_cndmask_b32 v254, v15, v14, s[46:47]
    v_mfma_f32_16x16x32_bf16 v[204:207], v[64:67], v[160:163], v[204:207]
    v_mfma_f32_16x16x32_bf16 v[188:191], v[68:71], v[132:135], v[188:191]
    v_mfma_f32_16x16x32_bf16 v[204:207], v[68:71], v[164:167], v[204:207]
    v_mfma_f32_16x16x32_bf16 v[188:191], v[72:75], v[136:139], v[188:191]
    v_mfma_f32_16x16x32_bf16 v[204:207], v[72:75], v[168:171], v[204:207]
    v_mfma_f32_16x16x32_bf16 v[188:191], v[76:79], v[140:143], v[188:191]
    v_mfma_f32_16x16x32_bf16 v[204:207], v[76:79], v[172:175], v[204:207]
    s_nop 6
    ds_bpermute_b32 v10, v240, v191
    ds_bpermute_b32 v13, v240, v207
    v_lshlrev_b32 v88, 16, v228
    v_add_f32 v250, v250, v88
    v_and_b32 v89, 0xffff0000, v228
    v_add_f32 v184, v184, v89
    v_lshlrev_b32 v90, 16, v229
    v_add_f32 v185, v185, v90
    v_and_b32 v91, 0xffff0000, v229
    v_add_f32 v186, v186, v91
    v_lshlrev_b32 v88, 16, v236
    v_add_f32 v254, v254, v88
    v_and_b32 v89, 0xffff0000, v236
    v_add_f32 v200, v200, v89
    v_lshlrev_b32 v90, 16, v237
    v_add_f32 v201, v201, v90
    v_and_b32 v91, 0xffff0000, v237
    v_add_f32 v202, v202, v91
    s_waitcnt lgkmcnt(1)
    v_cndmask_b32 v251, v10, v12, s[46:47]
    s_waitcnt lgkmcnt(0)
    v_cndmask_b32 v255, v13, v15, s[46:47]
    v_lshlrev_b32 v88, 16, v230
    v_add_f32 v251, v251, v88
    v_and_b32 v89, 0xffff0000, v230
    v_add_f32 v188, v188, v89
    v_lshlrev_b32 v90, 16, v231
    v_add_f32 v189, v189, v90
    v_and_b32 v91, 0xffff0000, v231
    v_add_f32 v190, v190, v91
    v_lshlrev_b32 v88, 16, v238
    v_add_f32 v255, v255, v88
    v_and_b32 v89, 0xffff0000, v238
    v_add_f32 v204, v204, v89
    v_lshlrev_b32 v90, 16, v239
    v_add_f32 v205, v205, v90
    v_and_b32 v91, 0xffff0000, v239
    v_add_f32 v206, v206, v91
    v_cvt_pk_bf16_f32 v100, v250, v184
    v_cvt_pk_bf16_f32 v101, v185, v186
    v_cvt_pk_bf16_f32 v102, v251, v188
    v_cvt_pk_bf16_f32 v103, v189, v190
    v_cvt_pk_bf16_f32 v108, v254, v200
    v_cvt_pk_bf16_f32 v109, v201, v202
    v_cvt_pk_bf16_f32 v110, v255, v204
    v_cvt_pk_bf16_f32 v111, v205, v206
    s_branch m_kernel_join
m_kernel_up:
    s_nop 7
    s_waitcnt lgkmcnt(15)
    v_mfma_f32_16x16x32_bf16 v[184:187], v[16:19], v[112:115], v[80:83]
    ds_read_b64_tr_b16 v[48:49], v219 offset:0
    ds_read_b64_tr_b16 v[50:51], v219 offset:512
    ds_read_b64_tr_b16 v[52:53], v219 offset:4096
    v_mfma_f32_16x16x32_bf16 v[200:203], v[16:19], v[144:147], v[84:87]
    ds_read_b64_tr_b16 v[54:55], v219 offset:4608
    ds_read_b64_tr_b16 v[56:57], v219 offset:8192
    ds_read_b64_tr_b16 v[58:59], v219 offset:8704
    v_mfma_f32_16x16x32_bf16 v[184:187], v[20:23], v[116:119], v[184:187]
    ds_read_b64_tr_b16 v[60:61], v219 offset:12288
    ds_read_b64_tr_b16 v[62:63], v219 offset:12800
    v_lshlrev_b32 v88, 16, v224
    v_mfma_f32_16x16x32_bf16 v[200:203], v[20:23], v[148:151], v[200:203]
    v_add_f32 v179, v179, v88
    v_and_b32 v89, 0xffff0000, v224
    v_add_f32 v178, v178, v89
    v_mfma_f32_16x16x32_bf16 v[184:187], v[24:27], v[120:123], v[184:187]
    v_lshlrev_b32 v90, 16, v225
    v_add_f32 v177, v177, v90
    v_and_b32 v91, 0xffff0000, v225
    v_mfma_f32_16x16x32_bf16 v[200:203], v[24:27], v[152:155], v[200:203]
    v_add_f32 v176, v176, v91
    s_waitcnt lgkmcnt(15)
    v_lshlrev_b32 v88, 16, v226
    v_add_f32 v183, v183, v88
    v_mfma_f32_16x16x32_bf16 v[184:187], v[28:31], v[124:127], v[184:187]
    v_and_b32 v89, 0xffff0000, v226
    v_add_f32 v182, v182, v89
    v_lshlrev_b32 v90, 16, v227
    v_mfma_f32_16x16x32_bf16 v[200:203], v[28:31], v[156:159], v[200:203]
    v_add_f32 v181, v181, v90
    v_and_b32 v91, 0xffff0000, v227
    v_add_f32 v180, v180, v91
    s_waitcnt lgkmcnt(14)
    v_mfma_f32_16x16x32_bf16 v[184:187], v[32:35], v[128:131], v[184:187]
    v_lshlrev_b32 v88, 16, v232
    v_add_f32 v195, v195, v88
    v_and_b32 v89, 0xffff0000, v232
    v_mfma_f32_16x16x32_bf16 v[200:203], v[32:35], v[160:163], v[200:203]
    v_add_f32 v194, v194, v89
    v_lshlrev_b32 v90, 16, v233
    v_add_f32 v193, v193, v90
    s_waitcnt lgkmcnt(12)
    v_mfma_f32_16x16x32_bf16 v[184:187], v[36:39], v[132:135], v[184:187]
    v_and_b32 v91, 0xffff0000, v233
    v_add_f32 v192, v192, v91
    v_lshlrev_b32 v88, 16, v234
    v_mfma_f32_16x16x32_bf16 v[200:203], v[36:39], v[164:167], v[200:203]
    v_add_f32 v199, v199, v88
    v_and_b32 v89, 0xffff0000, v234
    v_add_f32 v198, v198, v89
    s_waitcnt lgkmcnt(10)
    v_mfma_f32_16x16x32_bf16 v[184:187], v[40:43], v[136:139], v[184:187]
    v_lshlrev_b32 v90, 16, v235
    v_add_f32 v197, v197, v90
    v_and_b32 v91, 0xffff0000, v235
    v_mfma_f32_16x16x32_bf16 v[200:203], v[40:43], v[168:171], v[200:203]
    v_add_f32 v196, v196, v91
    v_cvt_pk_bf16_f32 v96, v179, v178
    v_cvt_pk_bf16_f32 v97, v177, v176
    s_waitcnt lgkmcnt(8)
    v_mfma_f32_16x16x32_bf16 v[184:187], v[44:47], v[140:143], v[184:187]
    v_cvt_pk_bf16_f32 v98, v183, v182
    v_cvt_pk_bf16_f32 v99, v181, v180
    buffer_store_dwordx4 v[96:99], v243, s[52:55], s14 offen offset:0 sc1
    v_mfma_f32_16x16x32_bf16 v[200:203], v[44:47], v[172:175], v[200:203]
    v_cvt_pk_bf16_f32 v104, v195, v194
    v_cvt_pk_bf16_f32 v105, v193, v192
    v_cvt_pk_bf16_f32 v106, v199, v198
    s_waitcnt lgkmcnt(6)
    v_mfma_f32_16x16x32_bf16 v[188:191], v[48:51], v[112:115], v[80:83]
    v_cvt_pk_bf16_f32 v107, v197, v196
    buffer_store_dwordx4 v[104:107], v243, s[52:55], s15 offen offset:0 sc1
    ds_read_b64_tr_b16 v[64:65], v219 offset:16384
    v_mfma_f32_16x16x32_bf16 v[204:207], v[48:51], v[144:147], v[84:87]
    ds_read_b64_tr_b16 v[66:67], v219 offset:16896
    ds_read_b64_tr_b16 v[68:69], v219 offset:20480
    ds_read_b64_tr_b16 v[70:71], v219 offset:20992
    s_waitcnt lgkmcnt(8)
    v_mfma_f32_16x16x32_bf16 v[188:191], v[52:55], v[116:119], v[188:191]
    ds_read_b64_tr_b16 v[72:73], v219 offset:24576
    ds_read_b64_tr_b16 v[74:75], v219 offset:25088
    ds_read_b64_tr_b16 v[76:77], v219 offset:28672
    v_mfma_f32_16x16x32_bf16 v[204:207], v[52:55], v[148:151], v[204:207]
    ds_read_b64_tr_b16 v[78:79], v219 offset:29184
    s_waitcnt lgkmcnt(10)
    v_mfma_f32_16x16x32_bf16 v[188:191], v[56:59], v[120:123], v[188:191]
    v_mfma_f32_16x16x32_bf16 v[204:207], v[56:59], v[152:155], v[204:207]
    s_waitcnt lgkmcnt(8)
    v_mfma_f32_16x16x32_bf16 v[188:191], v[60:63], v[124:127], v[188:191]
    v_mfma_f32_16x16x32_bf16 v[204:207], v[60:63], v[156:159], v[204:207]
    s_waitcnt lgkmcnt(6)
    v_mfma_f32_16x16x32_bf16 v[188:191], v[64:67], v[128:131], v[188:191]
    v_mfma_f32_16x16x32_bf16 v[204:207], v[64:67], v[160:163], v[204:207]
    s_waitcnt lgkmcnt(4)
    v_mfma_f32_16x16x32_bf16 v[188:191], v[68:71], v[132:135], v[188:191]
    v_mfma_f32_16x16x32_bf16 v[204:207], v[68:71], v[164:167], v[204:207]
    s_waitcnt lgkmcnt(2)
    v_mfma_f32_16x16x32_bf16 v[188:191], v[72:75], v[136:139], v[188:191]
    v_mfma_f32_16x16x32_bf16 v[204:207], v[72:75], v[168:171], v[204:207]
    s_waitcnt lgkmcnt(0)
    v_mfma_f32_16x16x32_bf16 v[188:191], v[76:79], v[140:143], v[188:191]
    v_mfma_f32_16x16x32_bf16 v[204:207], v[76:79], v[172:175], v[204:207]
    v_lshlrev_b32 v88, 16, v228
    v_add_f32 v187, v187, v88
    v_and_b32 v89, 0xffff0000, v228
    v_add_f32 v186, v186, v89
    v_lshlrev_b32 v90, 16, v229
    v_add_f32 v185, v185, v90
    v_and_b32 v91, 0xffff0000, v229
    v_add_f32 v184, v184, v91
    v_lshlrev_b32 v88, 16, v236
    v_add_f32 v203, v203, v88
    v_and_b32 v89, 0xffff0000, v236
    v_add_f32 v202, v202, v89
    v_lshlrev_b32 v90, 16, v237
    v_add_f32 v201, v201, v90
    v_and_b32 v91, 0xffff0000, v237
    v_add_f32 v200, v200, v91
    v_lshlrev_b32 v88, 16, v230
    v_add_f32 v191, v191, v88
    v_and_b32 v89, 0xffff0000, v230
    v_add_f32 v190, v190, v89
    v_lshlrev_b32 v90, 16, v231
    v_add_f32 v189, v189, v90
    v_and_b32 v91, 0xffff0000, v231
    v_add_f32 v188, v188, v91
    v_lshlrev_b32 v88, 16, v238
    v_add_f32 v207, v207, v88
    v_and_b32 v89, 0xffff0000, v238
    v_add_f32 v206, v206, v89
    v_lshlrev_b32 v90, 16, v239
    v_add_f32 v205, v205, v90
    v_and_b32 v91, 0xffff0000, v239
    v_add_f32 v204, v204, v91
    v_cvt_pk_bf16_f32 v100, v187, v186
    v_cvt_pk_bf16_f32 v101, v185, v184
    v_cvt_pk_bf16_f32 v102, v191, v190
    v_cvt_pk_bf16_f32 v103, v189, v188
    v_cvt_pk_bf16_f32 v108, v203, v202
    v_cvt_pk_bf16_f32 v109, v201, v200
    v_cvt_pk_bf16_f32 v110, v207, v206
    v_cvt_pk_bf16_f32 v111, v205, v204
m_kernel_join:
    s_waitcnt vmcnt(0)
    s_barrier
    v_dot2_f32_bf16 v5, v100, v4, v5
    v_dot2_f32_bf16 v6, v100, v100, v6
    v_dot2_f32_bf16 v5, v101, v4, v5
    v_dot2_f32_bf16 v6, v101, v101, v6
    v_dot2_f32_bf16 v5, v102, v4, v5
    v_dot2_f32_bf16 v6, v102, v102, v6
    buffer_store_dwordx4 v[100:103], v243, s[52:55], s14 offen offset:2048 sc1
    buffer_store_dwordx4 v[108:111], v243, s[52:55], s15 offen offset:2048 sc1
    v_dot2_f32_bf16 v5, v103, v4, v5
    v_dot2_f32_bf16 v6, v103, v103, v6
    v_dot2_f32_bf16 v7, v108, v4, v7
    v_dot2_f32_bf16 v8, v108, v108, v8
    v_dot2_f32_bf16 v7, v109, v4, v7
    v_dot2_f32_bf16 v8, v109, v109, v8
    v_dot2_f32_bf16 v7, v110, v4, v7
    v_dot2_f32_bf16 v8, v110, v110, v8
    v_dot2_f32_bf16 v7, v111, v4, v7
    v_dot2_f32_bf16 v8, v111, v111, v8
    v_dot2_f32_bf16 v5, v96, v4, v5
    v_dot2_f32_bf16 v6, v96, v96, v6
    v_dot2_f32_bf16 v5, v97, v4, v5
    v_dot2_f32_bf16 v6, v97, v97, v6
    v_dot2_f32_bf16 v5, v98, v4, v5
    v_dot2_f32_bf16 v6, v98, v98, v6
    v_dot2_f32_bf16 v5, v99, v4, v5
    v_dot2_f32_bf16 v6, v99, v99, v6
    v_dot2_f32_bf16 v7, v104, v4, v7
    v_dot2_f32_bf16 v8, v104, v104, v8
    v_dot2_f32_bf16 v7, v105, v4, v7
    v_dot2_f32_bf16 v8, v105, v105, v8
    v_dot2_f32_bf16 v7, v106, v4, v7
    v_dot2_f32_bf16 v8, v106, v106, v8
    v_dot2_f32_bf16 v7, v107, v4, v7
    v_dot2_f32_bf16 v8, v107, v107, v8
    buffer_store_dword v208, v9, s[32:35], s60 offen sc1
    buffer_store_dword v212, v9, s[32:35], s60 offen offset:256 sc1
    v_lshlrev_b32 v40, 3, v2
    v_lshrrev_b32 v41, 1, v3
    v_lshl_add_u32 v40, v41, 2, v40
    s_lshl_b32 s14, s10, 4
    s_add_u32 s14, s14, s11
    s_lshl_b32 s14, s14, 3
    s_add_u32 s14, s14, s12
    s_lshl_b32 s14, s14, 7
    s_add_u32 s28, s4, 28311552
    s_addc_u32 s29, s5, 0
    s_mov_b32 s30, 262144
    s_mov_b32 s31, 0x20000
    v_permlane32_swap_b32 v5, v6
    v_permlane32_swap_b32 v7, v8
    v_add_f32 v5, v5, v6
    v_add_f32 v7, v7, v8
    v_mov_b32 v6, v5
    v_mov_b32 v8, v7
    s_nop 0
    v_permlane16_swap_b32 v5, v6
    v_permlane16_swap_b32 v7, v8
    v_add_f32 v5, v5, v6
    v_add_f32 v7, v7, v8
    buffer_store_dword v5, v40, s[28:31], s14 offen offset:0 sc1
    buffer_store_dword v7, v40, s[28:31], s14 offen offset:512 sc1
    s_and_b32 s8, s2, 7
    s_lshr_b32 s9, s2, 3
    s_and_b32 s10, s8, 1
    s_lshl_b32 s10, s10, 3
    s_and_b32 s11, s9, 7
    s_add_u32 s10, s10, s11
    s_lshr_b32 s11, s8, 1
    s_lshl_b32 s11, s11, 2
    s_lshr_b32 s9, s9, 3
    s_add_u32 s11, s11, s9
    s_and_b32 s13, s12, 1
    s_lshr_b32 s14, s12, 1
    s_lshl_b32 s15, s13, 13
    v_lshlrev_b32 v2, 4, v1
    v_add_u32 v2, s15, v2
    v_lshrrev_b32 v48, 2, v1
    v_and_b32 v48, 7, v48
    v_and_b32 v49, 3, v1
    v_lshlrev_b32 v49, 3, v49
    v_lshrrev_b32 v50, 5, v1
    v_lshl_add_u32 v44, v48, 7, v49
    v_lshrrev_b32 v51, 1, v48
    v_lshl_add_u32 v44, v51, 5, v44
    v_mul_u32_u24 v51, 3072, v50
    v_add_u32 v44, v44, v51
    v_lshl_add_u32 v45, v48, 6, v49
    v_lshrrev_b32 v51, 2, v48
    v_lshl_add_u32 v45, v51, 5, v45
    v_lshl_add_u32 v45, v50, 9, v45
    s_cmp_lg_u32 s14, 0
    s_cselect_b64 vcc, -1, 0
    v_xor_b32 v46, 0, v44
    v_add_u32 v46, 50176, v46
    v_xor_b32 v47, 0, v44
    v_add_u32 v47, 51200, v47
    v_cndmask_b32 v208, v46, v47, vcc
    v_xor_b32 v46, 32, v44
    v_add_u32 v46, 50176, v46
    v_xor_b32 v47, 32, v44
    v_add_u32 v47, 51200, v47
    v_cndmask_b32 v209, v46, v47, vcc
    v_xor_b32 v46, 64, v44
    v_add_u32 v46, 49152, v46
    v_xor_b32 v47, 64, v44
    v_add_u32 v47, 51200, v47
    v_cndmask_b32 v210, v46, v47, vcc
    v_xor_b32 v46, 96, v44
    v_add_u32 v46, 49152, v46
    v_xor_b32 v47, 96, v44
    v_add_u32 v47, 51200, v47
    v_cndmask_b32 v211, v46, v47, vcc
    v_xor_b32 v46, 0, v44
    v_add_u32 v46, 49152, v46
    v_xor_b32 v47, 0, v45
    v_add_u32 v47, 55296, v47
    v_cndmask_b32 v212, v46, v47, vcc
    v_xor_b32 v46, 32, v44
    v_add_u32 v46, 49152, v46
    v_xor_b32 v47, 32, v45
    v_add_u32 v47, 55296, v47
    v_cndmask_b32 v213, v46, v47, vcc
    v_xor_b32 v46, 64, v44
    v_add_u32 v46, 50176, v46
    v_xor_b32 v47, 96, v44
    v_add_u32 v47, 50176, v47
    v_cndmask_b32 v214, v46, v47, vcc
    v_mov_b32 v3, v2
    v_mov_b32 v216, v208
    v_mov_b32 v217, v209
    v_mov_b32 v218, v210
    v_mov_b32 v219, v211
    v_mov_b32 v220, v212
    v_mov_b32 v221, v213
    v_mov_b32 v222, v214
    v_mov_b32 v64, 0
    v_mov_b32 v65, 0
    v_mov_b32 v66, 0
    v_mov_b32 v67, 0
    v_mov_b32 v68, 0
    v_mov_b32 v69, 0
    v_mov_b32 v70, 0
    v_mov_b32 v71, 0
    v_mov_b32 v72, 0
    v_mov_b32 v73, 0
    v_mov_b32 v74, 0
    v_mov_b32 v75, 0
    v_mov_b32 v76, 0
    v_mov_b32 v77, 0
    v_mov_b32 v78, 0
    v_mov_b32 v79, 0
    v_mov_b32 v80, 0
    v_mov_b32 v81, 0
    v_mov_b32 v82, 0
    v_mov_b32 v83, 0
    v_mov_b32 v84, 0
    v_mov_b32 v85, 0
    v_mov_b32 v86, 0
    v_mov_b32 v87, 0
    v_mov_b32 v88, 0
    v_mov_b32 v89, 0
    v_mov_b32 v90, 0
    v_mov_b32 v91, 0
    v_mov_b32 v92, 0
    v_mov_b32 v93, 0
    v_mov_b32 v94, 0
    v_mov_b32 v95, 0
    v_mov_b32 v96, 0
    v_mov_b32 v97, 0
    v_mov_b32 v98, 0
    v_mov_b32 v99, 0
    v_mov_b32 v100, 0
    v_mov_b32 v101, 0
    v_mov_b32 v102, 0
    v_mov_b32 v103, 0
    v_mov_b32 v104, 0
    v_mov_b32 v105, 0
    v_mov_b32 v106, 0
    v_mov_b32 v107, 0
    v_mov_b32 v108, 0
    v_mov_b32 v109, 0
    v_mov_b32 v110, 0
    v_mov_b32 v111, 0
    v_mov_b32 v112, 0
    v_mov_b32 v113, 0
    v_mov_b32 v114, 0
    v_mov_b32 v115, 0
    v_mov_b32 v116, 0
    v_mov_b32 v117, 0
    v_mov_b32 v118, 0
    v_mov_b32 v119, 0
    v_mov_b32 v120, 0
    v_mov_b32 v121, 0
    v_mov_b32 v122, 0
    v_mov_b32 v123, 0
    v_mov_b32 v124, 0
    v_mov_b32 v125, 0
    v_mov_b32 v126, 0
    v_mov_b32 v127, 0
    v_mov_b32 v128, 0
    v_mov_b32 v129, 0
    v_mov_b32 v130, 0
    v_mov_b32 v131, 0
    v_mov_b32 v132, 0
    v_mov_b32 v133, 0
    v_mov_b32 v134, 0
    v_mov_b32 v135, 0
    v_mov_b32 v136, 0
    v_mov_b32 v137, 0
    v_mov_b32 v138, 0
    v_mov_b32 v139, 0
    v_mov_b32 v140, 0
    v_mov_b32 v141, 0
    v_mov_b32 v142, 0
    v_mov_b32 v143, 0
    v_mov_b32 v144, 0
    v_mov_b32 v145, 0
    v_mov_b32 v146, 0
    v_mov_b32 v147, 0
    v_mov_b32 v148, 0
    v_mov_b32 v149, 0
    v_mov_b32 v150, 0
    v_mov_b32 v151, 0
    v_mov_b32 v152, 0
    v_mov_b32 v153, 0
    v_mov_b32 v154, 0
    v_mov_b32 v155, 0
    v_mov_b32 v156, 0
    v_mov_b32 v157, 0
    v_mov_b32 v158, 0
    v_mov_b32 v159, 0
    v_mov_b32 v160, 0
    v_mov_b32 v161, 0
    v_mov_b32 v162, 0
    v_mov_b32 v163, 0
    v_mov_b32 v164, 0
    v_mov_b32 v165, 0
    v_mov_b32 v166, 0
    v_mov_b32 v167, 0
    v_mov_b32 v168, 0
    v_mov_b32 v169, 0
    v_mov_b32 v170, 0
    v_mov_b32 v171, 0
    v_mov_b32 v172, 0
    v_mov_b32 v173, 0
    v_mov_b32 v174, 0
    v_mov_b32 v175, 0
    s_lshl_b32 s15, s10, 1
    s_add_u32 s15, s15, s13
    s_mul_i32 s15, s15, 688128
    s_add_u32 s15, s15, 41943040
    s_add_u32 s20, s4, s15
    s_addc_u32 s21, s5, 0
    s_mov_b32 s22, 688128
    s_mov_b32 s23, 0x20000
    s_mov_b32 s17, 0
    s_mov_b32 s19, 0
    s_mov_b32 s18, 0
    s_load_dwordx2 s[24:25], s[0:1], 56
    s_and_b32 s52, s11, 1
    s_mul_i32 s15, s11, 7
    s_add_u32 s16, s15, s52
    s_add_u32 s56, s16, 3
    s_cmp_lg_u32 s14, 0
    s_cselect_b32 s53, 4, 2
    s_cselect_b32 s54, 5, 1
    s_cselect_b32 s55, 6, 0
    s_add_u32 s53, s53, s16
    s_add_u32 s54, s54, s16
    s_add_u32 s55, s55, s16
    s_and_b32 s52, s52, s14
    s_cmp_lg_u32 s52, 0
    s_cselect_b32 s55, s15, s55
    s_lshl_b32 s57, s53, 6
    s_lshl_b32 s58, s54, 6
    s_lshl_b32 s59, s55, 6
    s_lshl_b32 s60, s56, 6
    s_lshl_b32 s15, s14, 5
    s_add_u32 s60, s60, s15
    v_and_b32 v44, 15, v1
    v_lshlrev_b32 v44, 1, v44
    s_mov_b32 s26, 7168
    s_mov_b32 s27, 0x20000
    s_waitcnt lgkmcnt(0)
    s_barrier
    s_waitcnt vmcnt(0)
    s_barrier
    ds_read_b128 v[176:179], v3 offset:0
    ds_read_b128 v[180:183], v3 offset:2048
    ds_read_b128 v[184:187], v3 offset:4096
    ds_read_b128 v[188:191], v3 offset:6144
    ds_read_b64_tr_b16 v[8:9], v216 offset:0
    ds_read_b64_tr_b16 v[10:11], v216 offset:7168
    ds_read_b64_tr_b16 v[12:13], v217 offset:0
    ds_read_b64_tr_b16 v[14:15], v217 offset:7168
    ds_read_b64_tr_b16 v[16:17], v218 offset:0
    ds_read_b64_tr_b16 v[18:19], v218 offset:7168
    ds_read_b64_tr_b16 v[20:21], v219 offset:0
    ds_read_b64_tr_b16 v[22:23], v219 offset:7168
    ds_read_b64_tr_b16 v[24:25], v220 offset:0
    ds_read_b64_tr_b16 v[26:27], v220 offset:7168
    ds_read_b64_tr_b16 v[28:29], v221 offset:0
    ds_read_b64_tr_b16 v[30:31], v221 offset:7168
    ds_read_b64_tr_b16 v[32:33], v222 offset:0
    ds_read_b64_tr_b16 v[34:35], v222 offset:7168
    buffer_load_ushort v240, v44, s[24:27], s57 offen offset:0
    buffer_load_ushort v241, v44, s[24:27], s57 offen offset:32
    buffer_load_ushort v242, v44, s[24:27], s58 offen offset:0
    buffer_load_ushort v243, v44, s[24:27], s58 offen offset:32
    buffer_load_ushort v244, v44, s[24:27], s59 offen offset:0
    buffer_load_ushort v245, v44, s[24:27], s59 offen offset:32
    buffer_load_ushort v246, v44, s[24:27], s60 offen offset:0
    s_waitcnt lgkmcnt(0)
    s_branch m_kernel_g1mid
.p2align 6
m_kernel_g1loop:
    s_barrier
    v_mfma_f32_16x16x32_bf16 v[64:67], v[36:39], v[192:195], v[64:67]
    ds_read_b128 v[176:179], v3 offset:0
    v_mfma_f32_16x16x32_bf16 v[68:71], v[36:39], v[196:199], v[68:71]
    ds_read_b128 v[180:183], v3 offset:2048
    v_mfma_f32_16x16x32_bf16 v[72:75], v[36:39], v[200:203], v[72:75]
    ds_read_b128 v[184:187], v3 offset:4096
    v_mfma_f32_16x16x32_bf16 v[76:79], v[36:39], v[204:207], v[76:79]
    ds_read_b128 v[188:191], v3 offset:6144
    v_mfma_f32_16x16x32_bf16 v[92:95], v[40:43], v[204:207], v[92:95]
    ds_read_b64_tr_b16 v[8:9], v216 offset:0
    v_mfma_f32_16x16x32_bf16 v[88:91], v[40:43], v[200:203], v[88:91]
    ds_read_b64_tr_b16 v[10:11], v216 offset:7168
    v_mfma_f32_16x16x32_bf16 v[84:87], v[40:43], v[196:199], v[84:87]
    ds_read_b64_tr_b16 v[12:13], v217 offset:0
    v_mfma_f32_16x16x32_bf16 v[80:83], v[40:43], v[192:195], v[80:83]
    ds_read_b64_tr_b16 v[14:15], v217 offset:7168
    v_mfma_f32_16x16x32_bf16 v[96:99], v[44:47], v[192:195], v[96:99]
    ds_read_b64_tr_b16 v[16:17], v218 offset:0
    v_mfma_f32_16x16x32_bf16 v[100:103], v[44:47], v[196:199], v[100:103]
    ds_read_b64_tr_b16 v[18:19], v218 offset:7168
    v_mfma_f32_16x16x32_bf16 v[104:107], v[44:47], v[200:203], v[104:107]
    ds_read_b64_tr_b16 v[20:21], v219 offset:0
    v_mfma_f32_16x16x32_bf16 v[108:111], v[44:47], v[204:207], v[108:111]
    ds_read_b64_tr_b16 v[22:23], v219 offset:7168
    v_mfma_f32_16x16x32_bf16 v[124:127], v[48:51], v[204:207], v[124:127]
    ds_read_b64_tr_b16 v[24:25], v220 offset:0
    v_mfma_f32_16x16x32_bf16 v[120:123], v[48:51], v[200:203], v[120:123]
    ds_read_b64_tr_b16 v[26:27], v220 offset:7168
    v_mfma_f32_16x16x32_bf16 v[116:119], v[48:51], v[196:199], v[116:119]
    ds_read_b64_tr_b16 v[28:29], v221 offset:0
    v_mfma_f32_16x16x32_bf16 v[112:115], v[48:51], v[192:195], v[112:115]
    ds_read_b64_tr_b16 v[30:31], v221 offset:7168
    v_mfma_f32_16x16x32_bf16 v[128:131], v[52:55], v[192:195], v[128:131]
    ds_read_b64_tr_b16 v[32:33], v222 offset:0
    v_mfma_f32_16x16x32_bf16 v[132:135], v[52:55], v[196:199], v[132:135]
    ds_read_b64_tr_b16 v[34:35], v222 offset:7168
    v_mfma_f32_16x16x32_bf16 v[136:139], v[52:55], v[200:203], v[136:139]
    v_mfma_f32_16x16x32_bf16 v[140:143], v[52:55], v[204:207], v[140:143]
    v_mfma_f32_16x16x32_bf16 v[156:159], v[56:59], v[204:207], v[156:159]
    v_mfma_f32_16x16x32_bf16 v[152:155], v[56:59], v[200:203], v[152:155]
    v_mfma_f32_16x16x32_bf16 v[148:151], v[56:59], v[196:199], v[148:151]
    v_mfma_f32_16x16x32_bf16 v[144:147], v[56:59], v[192:195], v[144:147]
    v_mfma_f32_16x16x32_bf16 v[160:163], v[60:63], v[192:195], v[160:163]
    v_mfma_f32_16x16x32_bf16 v[164:167], v[60:63], v[196:199], v[164:167]
    v_mfma_f32_16x16x32_bf16 v[168:171], v[60:63], v[200:203], v[168:171]
    v_mfma_f32_16x16x32_bf16 v[172:175], v[60:63], v[204:207], v[172:175]
m_kernel_g1mid:
    s_waitcnt lgkmcnt(12)
    v_mfma_f32_16x16x32_bf16 v[64:67], v[8:11], v[176:179], v[64:67]
    ds_read_b128 v[192:195], v3 offset:1024
    v_mfma_f32_16x16x32_bf16 v[68:71], v[8:11], v[180:183], v[68:71]
    ds_read_b128 v[196:199], v3 offset:3072
    v_mfma_f32_16x16x32_bf16 v[72:75], v[8:11], v[184:187], v[72:75]
    ds_read_b128 v[200:203], v3 offset:5120
    v_mfma_f32_16x16x32_bf16 v[76:79], v[8:11], v[188:191], v[76:79]
    ds_read_b128 v[204:207], v3 offset:7168
    s_waitcnt lgkmcnt(14)
    v_mfma_f32_16x16x32_bf16 v[92:95], v[12:15], v[188:191], v[92:95]
    ds_read_b64_tr_b16 v[36:37], v216 offset:14336
    v_mfma_f32_16x16x32_bf16 v[88:91], v[12:15], v[184:187], v[88:91]
    ds_read_b64_tr_b16 v[38:39], v216 offset:21504
    v_mfma_f32_16x16x32_bf16 v[84:87], v[12:15], v[180:183], v[84:87]
    ds_read_b64_tr_b16 v[40:41], v217 offset:14336
    v_mfma_f32_16x16x32_bf16 v[80:83], v[12:15], v[176:179], v[80:83]
    ds_read_b64_tr_b16 v[42:43], v217 offset:21504
    s_waitcnt lgkmcnt(15)
    v_mfma_f32_16x16x32_bf16 v[96:99], v[16:19], v[176:179], v[96:99]
    ds_read_b64_tr_b16 v[44:45], v218 offset:14336
    v_mfma_f32_16x16x32_bf16 v[100:103], v[16:19], v[180:183], v[100:103]
    ds_read_b64_tr_b16 v[46:47], v218 offset:21504
    v_mfma_f32_16x16x32_bf16 v[104:107], v[16:19], v[184:187], v[104:107]
    ds_read_b64_tr_b16 v[48:49], v219 offset:14336
    v_mfma_f32_16x16x32_bf16 v[108:111], v[16:19], v[188:191], v[108:111]
    ds_read_b64_tr_b16 v[50:51], v219 offset:21504
    s_waitcnt lgkmcnt(15)
    v_mfma_f32_16x16x32_bf16 v[124:127], v[20:23], v[188:191], v[124:127]
    ds_read_b64_tr_b16 v[52:53], v220 offset:14336
    v_mfma_f32_16x16x32_bf16 v[120:123], v[20:23], v[184:187], v[120:123]
    ds_read_b64_tr_b16 v[54:55], v220 offset:21504
    v_mfma_f32_16x16x32_bf16 v[116:119], v[20:23], v[180:183], v[116:119]
    ds_read_b64_tr_b16 v[56:57], v221 offset:14336
    v_mfma_f32_16x16x32_bf16 v[112:115], v[20:23], v[176:179], v[112:115]
    ds_read_b64_tr_b16 v[58:59], v221 offset:21504
    s_add_u32 s17, s17, 16384
    s_add_u32 s19, s19, 28672
    v_mfma_f32_16x16x32_bf16 v[128:131], v[24:27], v[176:179], v[128:131]
    ds_read_b64_tr_b16 v[60:61], v222 offset:14336
    s_cmp_eq_u32 s17, 49152
    s_cselect_b32 s17, 0, s17
    v_mfma_f32_16x16x32_bf16 v[132:135], v[24:27], v[180:183], v[132:135]
    ds_read_b64_tr_b16 v[62:63], v222 offset:21504
    s_cselect_b32 s19, 0, s19
    s_add_u32 s18, s18, 1
    v_mfma_f32_16x16x32_bf16 v[136:139], v[24:27], v[184:187], v[136:139]
    v_add_u32 v3, s17, v2
    s_cmp_le_u32 s18, 14
    v_mfma_f32_16x16x32_bf16 v[140:143], v[24:27], v[188:191], v[140:143]
    v_add_u32 v216, s19, v208
    s_waitcnt lgkmcnt(15)
    v_mfma_f32_16x16x32_bf16 v[156:159], v[28:31], v[188:191], v[156:159]
    v_add_u32 v217, s19, v209
    v_mfma_f32_16x16x32_bf16 v[152:155], v[28:31], v[184:187], v[152:155]
    v_add_u32 v218, s19, v210
    v_mfma_f32_16x16x32_bf16 v[148:151], v[28:31], v[180:183], v[148:151]
    v_add_u32 v219, s19, v211
    v_mfma_f32_16x16x32_bf16 v[144:147], v[28:31], v[176:179], v[144:147]
    v_add_u32 v220, s19, v212
    v_mfma_f32_16x16x32_bf16 v[160:163], v[32:35], v[176:179], v[160:163]
    v_add_u32 v221, s19, v213
    v_mfma_f32_16x16x32_bf16 v[164:167], v[32:35], v[180:183], v[164:167]
    v_add_u32 v222, s19, v214
    v_mfma_f32_16x16x32_bf16 v[168:171], v[32:35], v[184:187], v[168:171]
    v_mfma_f32_16x16x32_bf16 v[172:175], v[32:35], v[188:191], v[172:175]
    s_waitcnt lgkmcnt(0)
    s_cbranch_scc1 m_kernel_g1loop
    s_barrier
    v_and_b32 v2, 15, v1
    s_lshl_b32 s15, s13, 8
    s_add_u32 s15, s15, 136192
    v_lshl_add_u32 v2, v2, 2, s15
    v_mfma_f32_16x16x32_bf16 v[160:163], v[60:63], v[192:195], v[160:163]
    ds_read_b128 v[176:179], v3 offset:0
    ds_read_b128 v[180:183], v3 offset:2048
    ds_read_b128 v[184:187], v3 offset:4096
    ds_read_b128 v[188:191], v3 offset:6144
    ds_read_b64_tr_b16 v[8:9], v222 offset:0
    v_mfma_f32_16x16x32_bf16 v[164:167], v[60:63], v[196:199], v[164:167]
    ds_read_b64_tr_b16 v[10:11], v222 offset:7168
    ds_read_b64_tr_b16 v[12:13], v222 offset:14336
    ds_read_b64_tr_b16 v[14:15], v222 offset:21504
    ds_read_b128 v[224:227], v3 offset:1024
    ds_read_b128 v[228:231], v3 offset:3072
    v_mfma_f32_16x16x32_bf16 v[168:171], v[60:63], v[200:203], v[168:171]
    ds_read_b128 v[232:235], v3 offset:5120
    ds_read_b128 v[236:239], v3 offset:7168
    ds_read_b32 v208, v2 offset:0
    ds_read_b32 v212, v2 offset:64
    ds_read_b32 v248, v2 offset:128
    v_mfma_f32_16x16x32_bf16 v[172:175], v[60:63], v[204:207], v[172:175]
    ds_read_b32 v252, v2 offset:192
    ds_read_b64_tr_b16 v[16:17], v216 offset:0
    ds_read_b64_tr_b16 v[18:19], v216 offset:7168
    ds_read_b64_tr_b16 v[20:21], v216 offset:14336
    ds_read_b64_tr_b16 v[22:23], v216 offset:21504
    s_waitcnt lgkmcnt(14)
    v_mfma_f32_16x16x32_bf16 v[160:163], v[8:11], v[176:179], v[160:163]
    s_lshr_b32 s53, s53, 1
    s_mul_i32 s53, s53, 3072
    s_lshr_b32 s54, s54, 1
    s_mul_i32 s54, s54, 3072
    s_lshr_b32 s55, s55, 1
    v_mfma_f32_16x16x32_bf16 v[164:167], v[8:11], v[180:183], v[164:167]
    s_mul_i32 s55, s55, 3072
    s_lshr_b32 s56, s56, 1
    s_mul_i32 s56, s56, 3072
    v_and_b32 v4, 15, v1
    v_lshlrev_b32 v4, 4, v4
    v_mfma_f32_16x16x32_bf16 v[168:171], v[8:11], v[184:187], v[168:171]
    v_and_b32 v6, 16, v1
    v_and_b32 v7, 32, v1
    v_lshl_add_u32 v5, v7, 3, v4
    v_lshl_add_u32 v4, v6, 5, v5
    s_lshl_b32 s19, s14, 9
    v_mfma_f32_16x16x32_bf16 v[172:175], v[8:11], v[188:191], v[172:175]
    v_add_u32 v5, s19, v5
    v_cmp_lt_u32 vcc, 255, v5
    v_add_u32 v5, 1152, v5
    v_add_u32 v2, 128, v5
    v_cndmask_b32 v5, v5, v2, vcc
    s_waitcnt lgkmcnt(8)
    v_mfma_f32_16x16x32_bf16 v[160:163], v[12:15], v[224:227], v[160:163]
    v_mul_u32_u24 v6, 10752, v6
    v_add_u32 v5, v5, v6
    v_cmp_lt_u32 vcc, 255, v4
    v_add_u32 v6, 1152, v4
    v_add_u32 v2, 128, v6
    v_mfma_f32_16x16x32_bf16 v[164:167], v[12:15], v[228:231], v[164:167]
    v_cndmask_b32 v6, v6, v2, vcc
    v_cmp_lt_u32 vcc, 383, v4
    v_add_u32 v2, 128, v4
    s_nop 0
    v_cndmask_b32 v4, v4, v2, vcc
    s_cmp_lg_u32 s52, 0
    v_mfma_f32_16x16x32_bf16 v[168:171], v[12:15], v[232:235], v[168:171]
    s_cselect_b64 vcc, -1, 0
    v_cndmask_b32 v7, v4, v6, vcc
    v_mov_b32 v209, 0
    v_mov_b32 v210, 0
    v_mov_b32 v211, 0
    v_mfma_f32_16x16x32_bf16 v[172:175], v[12:15], v[236:239], v[172:175]
    v_mov_b32 v213, 0
    v_mov_b32 v214, 0
    v_mov_b32 v215, 0
    v_mov_b32 v249, 0
    v_mov_b32 v250, 0
    v_mov_b32 v251, 0
    v_mov_b32 v253, 0
    v_mov_b32 v254, 0
    v_mov_b32 v255, 0
    v_mov_b32 v33, 0
    v_mov_b32 v34, 0
    v_mov_b32 v35, 0
    s_waitcnt vmcnt(0) lgkmcnt(4)
    v_cmp_gt_u32 vcc, 16, v1
    s_nop 1
    v_cndmask_b32 v208, 0, v208, vcc
    v_cndmask_b32 v212, 0, v212, vcc
    v_cndmask_b32 v248, 0, v248, vcc
    v_cndmask_b32 v252, 0, v252, vcc
    v_mov_b32 v32, v246
    s_nop 1
    v_mfma_f32_16x16x32_bf16 v[160:163], v[32:35], v[208:211], v[160:163]
    v_mfma_f32_16x16x32_bf16 v[164:167], v[32:35], v[212:215], v[164:167]
    v_mfma_f32_16x16x32_bf16 v[168:171], v[32:35], v[248:251], v[168:171]
    v_mfma_f32_16x16x32_bf16 v[172:175], v[32:35], v[252:255], v[172:175]
    v_mfma_f32_16x16x32_bf16 v[64:67], v[36:39], v[192:195], v[64:67]
    ds_read_b64_tr_b16 v[24:25], v217 offset:0
    ds_read_b64_tr_b16 v[26:27], v217 offset:7168
    ds_read_b64_tr_b16 v[28:29], v217 offset:14336
    v_mfma_f32_16x16x32_bf16 v[68:71], v[36:39], v[196:199], v[68:71]
    ds_read_b64_tr_b16 v[30:31], v217 offset:21504
    v_mul_f32 v160, v160, abs(v160)
    v_mul_f32 v161, v161, abs(v161)
    v_mfma_f32_16x16x32_bf16 v[72:75], v[36:39], v[200:203], v[72:75]
    v_mul_f32 v162, v162, abs(v162)
    v_mul_f32 v163, v163, abs(v163)
    v_mul_f32 v164, v164, abs(v164)
    v_mfma_f32_16x16x32_bf16 v[76:79], v[36:39], v[204:207], v[76:79]
    v_mul_f32 v165, v165, abs(v165)
    v_mul_f32 v166, v166, abs(v166)
    v_mul_f32 v167, v167, abs(v167)
    s_waitcnt lgkmcnt(4)
    v_mfma_f32_16x16x32_bf16 v[64:67], v[16:19], v[176:179], v[64:67]
    v_cvt_pk_bf16_f32 v160, v160, v161
    v_cvt_pk_bf16_f32 v161, v162, v163
    v_cvt_pk_bf16_f32 v162, v164, v165
    v_mfma_f32_16x16x32_bf16 v[68:71], v[16:19], v[180:183], v[68:71]
    v_cvt_pk_bf16_f32 v163, v166, v167
    v_pk_max_i16 v160, v160, 0
    v_pk_max_i16 v161, v161, 0
    v_mfma_f32_16x16x32_bf16 v[72:75], v[16:19], v[184:187], v[72:75]
    v_pk_max_i16 v162, v162, 0
    v_pk_max_i16 v163, v163, 0
    s_nop 0
    v_permlane16_swap_b32 v160, v162
    v_mfma_f32_16x16x32_bf16 v[76:79], v[16:19], v[188:191], v[76:79]
    v_permlane16_swap_b32 v161, v163
    buffer_store_dwordx4 v[160:163], v5, s[20:23], s56 offen sc1
    s_add_u32 s56, s56, 344064
    v_mfma_f32_16x16x32_bf16 v[64:67], v[20:23], v[224:227], v[64:67]
    v_mul_f32 v168, v168, abs(v168)
    v_mul_f32 v169, v169, abs(v169)
    v_mul_f32 v170, v170, abs(v170)
    v_mfma_f32_16x16x32_bf16 v[68:71], v[20:23], v[228:231], v[68:71]
    v_mul_f32 v171, v171, abs(v171)
    v_mul_f32 v172, v172, abs(v172)
    v_mul_f32 v173, v173, abs(v173)
    v_mov_b32 v32, v240
    v_mfma_f32_16x16x32_bf16 v[72:75], v[20:23], v[232:235], v[72:75]
    v_mul_f32 v174, v174, abs(v174)
    v_mul_f32 v175, v175, abs(v175)
    v_cvt_pk_bf16_f32 v168, v168, v169
    v_mfma_f32_16x16x32_bf16 v[76:79], v[20:23], v[236:239], v[76:79]
    v_cvt_pk_bf16_f32 v169, v170, v171
    v_cvt_pk_bf16_f32 v170, v172, v173
    v_cvt_pk_bf16_f32 v171, v174, v175
    v_mfma_f32_16x16x32_bf16 v[64:67], v[32:35], v[208:211], v[64:67]
    v_pk_max_i16 v168, v168, 0
    v_pk_max_i16 v169, v169, 0
    v_pk_max_i16 v170, v170, 0
    v_mfma_f32_16x16x32_bf16 v[68:71], v[32:35], v[212:215], v[68:71]
    v_pk_max_i16 v171, v171, 0
    v_permlane16_swap_b32 v168, v170
    s_nop 0
    v_permlane16_swap_b32 v169, v171
    v_mfma_f32_16x16x32_bf16 v[72:75], v[32:35], v[248:251], v[72:75]
    buffer_store_dwordx4 v[168:171], v5, s[20:23], s56 offen sc1
    v_mfma_f32_16x16x32_bf16 v[76:79], v[32:35], v[252:255], v[76:79]
    v_mfma_f32_16x16x32_bf16 v[80:83], v[40:43], v[192:195], v[80:83]
    ds_read_b64_tr_b16 v[8:9], v218 offset:0
    ds_read_b64_tr_b16 v[10:11], v218 offset:7168
    ds_read_b64_tr_b16 v[12:13], v218 offset:14336
    v_mfma_f32_16x16x32_bf16 v[84:87], v[40:43], v[196:199], v[84:87]
    ds_read_b64_tr_b16 v[14:15], v218 offset:21504
    v_mul_f32 v64, v64, abs(v64)
    v_mul_f32 v65, v65, abs(v65)
    v_mfma_f32_16x16x32_bf16 v[88:91], v[40:43], v[200:203], v[88:91]
    v_mul_f32 v66, v66, abs(v66)
    v_mul_f32 v67, v67, abs(v67)
    v_mul_f32 v68, v68, abs(v68)
    v_mfma_f32_16x16x32_bf16 v[92:95], v[40:43], v[204:207], v[92:95]
    v_mul_f32 v69, v69, abs(v69)
    v_mul_f32 v70, v70, abs(v70)
    v_mul_f32 v71, v71, abs(v71)
    s_waitcnt lgkmcnt(4)
    v_mfma_f32_16x16x32_bf16 v[80:83], v[24:27], v[176:179], v[80:83]
    v_cvt_pk_bf16_f32 v64, v64, v65
    v_cvt_pk_bf16_f32 v65, v66, v67
    v_cvt_pk_bf16_f32 v68, v68, v69
    v_mfma_f32_16x16x32_bf16 v[84:87], v[24:27], v[180:183], v[84:87]
    v_cvt_pk_bf16_f32 v69, v70, v71
    v_pk_max_i16 v64, v64, 0
    v_pk_max_i16 v65, v65, 0
    v_mfma_f32_16x16x32_bf16 v[88:91], v[24:27], v[184:187], v[88:91]
    v_pk_max_i16 v68, v68, 0
    v_pk_max_i16 v69, v69, 0
    v_mul_f32 v72, v72, abs(v72)
    v_mfma_f32_16x16x32_bf16 v[92:95], v[24:27], v[188:191], v[92:95]
    v_mul_f32 v73, v73, abs(v73)
    v_mul_f32 v74, v74, abs(v74)
    v_mul_f32 v75, v75, abs(v75)
    v_mfma_f32_16x16x32_bf16 v[80:83], v[28:31], v[224:227], v[80:83]
    v_mul_f32 v76, v76, abs(v76)
    v_mul_f32 v77, v77, abs(v77)
    v_mul_f32 v78, v78, abs(v78)
    v_mfma_f32_16x16x32_bf16 v[84:87], v[28:31], v[228:231], v[84:87]
    v_mul_f32 v79, v79, abs(v79)
    v_cvt_pk_bf16_f32 v72, v72, v73
    v_cvt_pk_bf16_f32 v73, v74, v75
    v_mov_b32 v32, v241
    v_mfma_f32_16x16x32_bf16 v[88:91], v[28:31], v[232:235], v[88:91]
    v_cvt_pk_bf16_f32 v76, v76, v77
    v_cvt_pk_bf16_f32 v77, v78, v79
    v_pk_max_i16 v72, v72, 0
    v_mfma_f32_16x16x32_bf16 v[92:95], v[28:31], v[236:239], v[92:95]
    v_pk_max_i16 v73, v73, 0
    v_pk_max_i16 v76, v76, 0
    v_pk_max_i16 v77, v77, 0
    v_mfma_f32_16x16x32_bf16 v[80:83], v[32:35], v[208:211], v[80:83]
    v_mfma_f32_16x16x32_bf16 v[84:87], v[32:35], v[212:215], v[84:87]
    v_mfma_f32_16x16x32_bf16 v[88:91], v[32:35], v[248:251], v[88:91]
    v_mfma_f32_16x16x32_bf16 v[92:95], v[32:35], v[252:255], v[92:95]
    v_mfma_f32_16x16x32_bf16 v[96:99], v[44:47], v[192:195], v[96:99]
    ds_read_b64_tr_b16 v[16:17], v219 offset:0
    ds_read_b64_tr_b16 v[18:19], v219 offset:7168
    ds_read_b64_tr_b16 v[20:21], v219 offset:14336
    ds_read_b64_tr_b16 v[22:23], v219 offset:21504
    v_mfma_f32_16x16x32_bf16 v[100:103], v[44:47], v[196:199], v[100:103]
    v_mul_f32 v80, v80, abs(v80)
    v_mul_f32 v81, v81, abs(v81)
    v_mul_f32 v82, v82, abs(v82)
    v_mul_f32 v83, v83, abs(v83)
    v_mfma_f32_16x16x32_bf16 v[104:107], v[44:47], v[200:203], v[104:107]
    v_mul_f32 v84, v84, abs(v84)
    v_mul_f32 v85, v85, abs(v85)
    v_mul_f32 v86, v86, abs(v86)
    v_mul_f32 v87, v87, abs(v87)
    v_mfma_f32_16x16x32_bf16 v[108:111], v[44:47], v[204:207], v[108:111]
    v_cvt_pk_bf16_f32 v66, v80, v81
    v_cvt_pk_bf16_f32 v67, v82, v83
    v_cvt_pk_bf16_f32 v70, v84, v85
    v_cvt_pk_bf16_f32 v71, v86, v87
    s_waitcnt lgkmcnt(4)
    v_mfma_f32_16x16x32_bf16 v[96:99], v[8:11], v[176:179], v[96:99]
    v_pk_max_i16 v66, v66, 0
    v_pk_max_i16 v67, v67, 0
    v_pk_max_i16 v70, v70, 0
    v_pk_max_i16 v71, v71, 0
    v_mfma_f32_16x16x32_bf16 v[100:103], v[8:11], v[180:183], v[100:103]
    v_permlane16_swap_b32 v64, v66
    v_permlane16_swap_b32 v65, v67
    v_permlane16_swap_b32 v68, v70
    v_permlane16_swap_b32 v69, v71
    v_mfma_f32_16x16x32_bf16 v[104:107], v[8:11], v[184:187], v[104:107]
    buffer_store_dwordx4 v[64:67], v4, s[20:23], s53 offen sc1
    s_add_u32 s53, s53, 172032
    buffer_store_dwordx4 v[68:71], v4, s[20:23], s53 offen sc1
    s_add_u32 s53, s53, 172032
    v_mfma_f32_16x16x32_bf16 v[108:111], v[8:11], v[188:191], v[108:111]
    v_mul_f32 v88, v88, abs(v88)
    v_mul_f32 v89, v89, abs(v89)
    v_mul_f32 v90, v90, abs(v90)
    v_mul_f32 v91, v91, abs(v91)
    v_mfma_f32_16x16x32_bf16 v[96:99], v[12:15], v[224:227], v[96:99]
    v_mul_f32 v92, v92, abs(v92)
    v_mul_f32 v93, v93, abs(v93)
    v_mul_f32 v94, v94, abs(v94)
    v_mul_f32 v95, v95, abs(v95)
    v_mfma_f32_16x16x32_bf16 v[100:103], v[12:15], v[228:231], v[100:103]
    v_cvt_pk_bf16_f32 v74, v88, v89
    v_cvt_pk_bf16_f32 v75, v90, v91
    v_cvt_pk_bf16_f32 v78, v92, v93
    v_cvt_pk_bf16_f32 v79, v94, v95
    v_mov_b32 v32, v242
    v_mfma_f32_16x16x32_bf16 v[104:107], v[12:15], v[232:235], v[104:107]
    v_pk_max_i16 v74, v74, 0
    v_pk_max_i16 v75, v75, 0
    v_pk_max_i16 v78, v78, 0
    v_pk_max_i16 v79, v79, 0
    v_mfma_f32_16x16x32_bf16 v[108:111], v[12:15], v[236:239], v[108:111]
    v_permlane16_swap_b32 v72, v74
    v_permlane16_swap_b32 v73, v75
    v_permlane16_swap_b32 v76, v78
    v_permlane16_swap_b32 v77, v79
    v_mfma_f32_16x16x32_bf16 v[96:99], v[32:35], v[208:211], v[96:99]
    buffer_store_dwordx4 v[72:75], v4, s[20:23], s53 offen sc1
    s_add_u32 s53, s53, 172032
    buffer_store_dwordx4 v[76:79], v4, s[20:23], s53 offen sc1
    v_mfma_f32_16x16x32_bf16 v[100:103], v[32:35], v[212:215], v[100:103]
    v_mfma_f32_16x16x32_bf16 v[104:107], v[32:35], v[248:251], v[104:107]
    v_mfma_f32_16x16x32_bf16 v[108:111], v[32:35], v[252:255], v[108:111]
    v_mfma_f32_16x16x32_bf16 v[112:115], v[48:51], v[192:195], v[112:115]
    ds_read_b64_tr_b16 v[24:25], v220 offset:0
    ds_read_b64_tr_b16 v[26:27], v220 offset:7168
    ds_read_b64_tr_b16 v[28:29], v220 offset:14336
    v_mfma_f32_16x16x32_bf16 v[116:119], v[48:51], v[196:199], v[116:119]
    ds_read_b64_tr_b16 v[30:31], v220 offset:21504
    v_mul_f32 v96, v96, abs(v96)
    v_mul_f32 v97, v97, abs(v97)
    v_mfma_f32_16x16x32_bf16 v[120:123], v[48:51], v[200:203], v[120:123]
    v_mul_f32 v98, v98, abs(v98)
    v_mul_f32 v99, v99, abs(v99)
    v_mul_f32 v100, v100, abs(v100)
    v_mfma_f32_16x16x32_bf16 v[124:127], v[48:51], v[204:207], v[124:127]
    v_mul_f32 v101, v101, abs(v101)
    v_mul_f32 v102, v102, abs(v102)
    v_mul_f32 v103, v103, abs(v103)
    s_waitcnt lgkmcnt(4)
    v_mfma_f32_16x16x32_bf16 v[112:115], v[16:19], v[176:179], v[112:115]
    v_cvt_pk_bf16_f32 v96, v96, v97
    v_cvt_pk_bf16_f32 v97, v98, v99
    v_cvt_pk_bf16_f32 v100, v100, v101
    v_mfma_f32_16x16x32_bf16 v[116:119], v[16:19], v[180:183], v[116:119]
    v_cvt_pk_bf16_f32 v101, v102, v103
    v_pk_max_i16 v96, v96, 0
    v_pk_max_i16 v97, v97, 0
    v_mfma_f32_16x16x32_bf16 v[120:123], v[16:19], v[184:187], v[120:123]
    v_pk_max_i16 v100, v100, 0
    v_pk_max_i16 v101, v101, 0
    v_mul_f32 v104, v104, abs(v104)
    v_mfma_f32_16x16x32_bf16 v[124:127], v[16:19], v[188:191], v[124:127]
    v_mul_f32 v105, v105, abs(v105)
    v_mul_f32 v106, v106, abs(v106)
    v_mul_f32 v107, v107, abs(v107)
    v_mfma_f32_16x16x32_bf16 v[112:115], v[20:23], v[224:227], v[112:115]
    v_mul_f32 v108, v108, abs(v108)
    v_mul_f32 v109, v109, abs(v109)
    v_mul_f32 v110, v110, abs(v110)
    v_mfma_f32_16x16x32_bf16 v[116:119], v[20:23], v[228:231], v[116:119]
    v_mul_f32 v111, v111, abs(v111)
    v_cvt_pk_bf16_f32 v104, v104, v105
    v_cvt_pk_bf16_f32 v105, v106, v107
    v_mov_b32 v32, v243
    v_mfma_f32_16x16x32_bf16 v[120:123], v[20:23], v[232:235], v[120:123]
    v_cvt_pk_bf16_f32 v108, v108, v109
    v_cvt_pk_bf16_f32 v109, v110, v111
    v_pk_max_i16 v104, v104, 0
    v_mfma_f32_16x16x32_bf16 v[124:127], v[20:23], v[236:239], v[124:127]
    v_pk_max_i16 v105, v105, 0
    v_pk_max_i16 v108, v108, 0
    v_pk_max_i16 v109, v109, 0
    v_mfma_f32_16x16x32_bf16 v[112:115], v[32:35], v[208:211], v[112:115]
    v_mfma_f32_16x16x32_bf16 v[116:119], v[32:35], v[212:215], v[116:119]
    v_mfma_f32_16x16x32_bf16 v[120:123], v[32:35], v[248:251], v[120:123]
    v_mfma_f32_16x16x32_bf16 v[124:127], v[32:35], v[252:255], v[124:127]
    v_mfma_f32_16x16x32_bf16 v[128:131], v[52:55], v[192:195], v[128:131]
    ds_read_b64_tr_b16 v[8:9], v221 offset:0
    ds_read_b64_tr_b16 v[10:11], v221 offset:7168
    ds_read_b64_tr_b16 v[12:13], v221 offset:14336
    ds_read_b64_tr_b16 v[14:15], v221 offset:21504
    v_mfma_f32_16x16x32_bf16 v[132:135], v[52:55], v[196:199], v[132:135]
    v_mul_f32 v112, v112, abs(v112)
    v_mul_f32 v113, v113, abs(v113)
    v_mul_f32 v114, v114, abs(v114)
    v_mul_f32 v115, v115, abs(v115)
    v_mfma_f32_16x16x32_bf16 v[136:139], v[52:55], v[200:203], v[136:139]
    v_mul_f32 v116, v116, abs(v116)
    v_mul_f32 v117, v117, abs(v117)
    v_mul_f32 v118, v118, abs(v118)
    v_mul_f32 v119, v119, abs(v119)
    v_mfma_f32_16x16x32_bf16 v[140:143], v[52:55], v[204:207], v[140:143]
    v_cvt_pk_bf16_f32 v98, v112, v113
    v_cvt_pk_bf16_f32 v99, v114, v115
    v_cvt_pk_bf16_f32 v102, v116, v117
    v_cvt_pk_bf16_f32 v103, v118, v119
    s_waitcnt lgkmcnt(4)
    v_mfma_f32_16x16x32_bf16 v[128:131], v[24:27], v[176:179], v[128:131]
    v_pk_max_i16 v98, v98, 0
    v_pk_max_i16 v99, v99, 0
    v_pk_max_i16 v102, v102, 0
    v_pk_max_i16 v103, v103, 0
    v_mfma_f32_16x16x32_bf16 v[132:135], v[24:27], v[180:183], v[132:135]
    v_permlane16_swap_b32 v96, v98
    v_permlane16_swap_b32 v97, v99
    v_permlane16_swap_b32 v100, v102
    v_permlane16_swap_b32 v101, v103
    v_mfma_f32_16x16x32_bf16 v[136:139], v[24:27], v[184:187], v[136:139]
    buffer_store_dwordx4 v[96:99], v6, s[20:23], s54 offen sc1
    s_add_u32 s54, s54, 172032
    buffer_store_dwordx4 v[100:103], v6, s[20:23], s54 offen sc1
    s_add_u32 s54, s54, 172032
    v_mfma_f32_16x16x32_bf16 v[140:143], v[24:27], v[188:191], v[140:143]
    v_mul_f32 v120, v120, abs(v120)
    v_mul_f32 v121, v121, abs(v121)
    v_mul_f32 v122, v122, abs(v122)
    v_mul_f32 v123, v123, abs(v123)
    v_mfma_f32_16x16x32_bf16 v[128:131], v[28:31], v[224:227], v[128:131]
    v_mul_f32 v124, v124, abs(v124)
    v_mul_f32 v125, v125, abs(v125)
    v_mul_f32 v126, v126, abs(v126)
    v_mul_f32 v127, v127, abs(v127)
    v_mfma_f32_16x16x32_bf16 v[132:135], v[28:31], v[228:231], v[132:135]
    v_cvt_pk_bf16_f32 v106, v120, v121
    v_cvt_pk_bf16_f32 v107, v122, v123
    v_cvt_pk_bf16_f32 v110, v124, v125
    v_cvt_pk_bf16_f32 v111, v126, v127
    v_mov_b32 v32, v244
    v_mfma_f32_16x16x32_bf16 v[136:139], v[28:31], v[232:235], v[136:139]
    v_pk_max_i16 v106, v106, 0
    v_pk_max_i16 v107, v107, 0
    v_pk_max_i16 v110, v110, 0
    v_pk_max_i16 v111, v111, 0
    v_mfma_f32_16x16x32_bf16 v[140:143], v[28:31], v[236:239], v[140:143]
    v_permlane16_swap_b32 v104, v106
    v_permlane16_swap_b32 v105, v107
    v_permlane16_swap_b32 v108, v110
    v_permlane16_swap_b32 v109, v111
    v_mfma_f32_16x16x32_bf16 v[128:131], v[32:35], v[208:211], v[128:131]
    buffer_store_dwordx4 v[104:107], v6, s[20:23], s54 offen sc1
    s_add_u32 s54, s54, 172032
    buffer_store_dwordx4 v[108:111], v6, s[20:23], s54 offen sc1
    v_mfma_f32_16x16x32_bf16 v[132:135], v[32:35], v[212:215], v[132:135]
    v_mfma_f32_16x16x32_bf16 v[136:139], v[32:35], v[248:251], v[136:139]
    v_mfma_f32_16x16x32_bf16 v[140:143], v[32:35], v[252:255], v[140:143]
    v_mfma_f32_16x16x32_bf16 v[144:147], v[56:59], v[192:195], v[144:147]
    s_nop 0
    v_mul_f32 v128, v128, abs(v128)
    v_mul_f32 v129, v129, abs(v129)
    v_mul_f32 v130, v130, abs(v130)
    v_mfma_f32_16x16x32_bf16 v[148:151], v[56:59], v[196:199], v[148:151]
    v_mul_f32 v131, v131, abs(v131)
    v_mul_f32 v132, v132, abs(v132)
    v_mul_f32 v133, v133, abs(v133)
    v_mfma_f32_16x16x32_bf16 v[152:155], v[56:59], v[200:203], v[152:155]
    v_mul_f32 v134, v134, abs(v134)
    v_mul_f32 v135, v135, abs(v135)
    v_cvt_pk_bf16_f32 v128, v128, v129
    v_mfma_f32_16x16x32_bf16 v[156:159], v[56:59], v[204:207], v[156:159]
    v_cvt_pk_bf16_f32 v129, v130, v131
    v_cvt_pk_bf16_f32 v132, v132, v133
    v_cvt_pk_bf16_f32 v133, v134, v135
    s_waitcnt lgkmcnt(0)
    v_mfma_f32_16x16x32_bf16 v[144:147], v[8:11], v[176:179], v[144:147]
    s_barrier
    v_pk_max_i16 v128, v128, 0
    v_pk_max_i16 v129, v129, 0
    v_pk_max_i16 v132, v132, 0
    v_mfma_f32_16x16x32_bf16 v[148:151], v[8:11], v[180:183], v[148:151]
    v_pk_max_i16 v133, v133, 0
    v_mul_f32 v136, v136, abs(v136)
    v_mul_f32 v137, v137, abs(v137)
    v_mfma_f32_16x16x32_bf16 v[152:155], v[8:11], v[184:187], v[152:155]
    v_mul_f32 v138, v138, abs(v138)
    v_mul_f32 v139, v139, abs(v139)
    v_mul_f32 v140, v140, abs(v140)
    v_mfma_f32_16x16x32_bf16 v[156:159], v[8:11], v[188:191], v[156:159]
    v_mul_f32 v141, v141, abs(v141)
    v_mul_f32 v142, v142, abs(v142)
    v_mul_f32 v143, v143, abs(v143)
    v_mfma_f32_16x16x32_bf16 v[144:147], v[12:15], v[224:227], v[144:147]
    v_cvt_pk_bf16_f32 v136, v136, v137
    v_cvt_pk_bf16_f32 v137, v138, v139
    v_cvt_pk_bf16_f32 v140, v140, v141
    v_mfma_f32_16x16x32_bf16 v[148:151], v[12:15], v[228:231], v[148:151]
    v_cvt_pk_bf16_f32 v141, v142, v143
    v_pk_max_i16 v136, v136, 0
    v_pk_max_i16 v137, v137, 0
    v_mov_b32 v32, v245
    v_mfma_f32_16x16x32_bf16 v[152:155], v[12:15], v[232:235], v[152:155]
    v_pk_max_i16 v140, v140, 0
    v_pk_max_i16 v141, v141, 0
    v_mfma_f32_16x16x32_bf16 v[156:159], v[12:15], v[236:239], v[156:159]
    v_mfma_f32_16x16x32_bf16 v[144:147], v[32:35], v[208:211], v[144:147]
    v_mfma_f32_16x16x32_bf16 v[148:151], v[32:35], v[212:215], v[148:151]
    v_mfma_f32_16x16x32_bf16 v[152:155], v[32:35], v[248:251], v[152:155]
    v_mfma_f32_16x16x32_bf16 v[156:159], v[32:35], v[252:255], v[156:159]
    s_nop 4
    v_mul_f32 v144, v144, abs(v144)
    v_mul_f32 v145, v145, abs(v145)
    v_mul_f32 v146, v146, abs(v146)
    v_mul_f32 v147, v147, abs(v147)
    v_mul_f32 v148, v148, abs(v148)
    v_mul_f32 v149, v149, abs(v149)
    v_mul_f32 v150, v150, abs(v150)
    v_mul_f32 v151, v151, abs(v151)
    v_cvt_pk_bf16_f32 v130, v144, v145
    v_cvt_pk_bf16_f32 v131, v146, v147
    v_cvt_pk_bf16_f32 v134, v148, v149
    v_cvt_pk_bf16_f32 v135, v150, v151
    v_pk_max_i16 v130, v130, 0
    v_pk_max_i16 v131, v131, 0
    v_pk_max_i16 v134, v134, 0
    v_pk_max_i16 v135, v135, 0
    v_permlane16_swap_b32 v128, v130
    v_permlane16_swap_b32 v129, v131
    v_permlane16_swap_b32 v132, v134
    v_permlane16_swap_b32 v133, v135
    v_mul_f32 v152, v152, abs(v152)
    v_mul_f32 v153, v153, abs(v153)
    v_mul_f32 v154, v154, abs(v154)
    v_mul_f32 v155, v155, abs(v155)
    v_mul_f32 v156, v156, abs(v156)
    v_mul_f32 v157, v157, abs(v157)
    v_mul_f32 v158, v158, abs(v158)
    v_mul_f32 v159, v159, abs(v159)
    v_cvt_pk_bf16_f32 v138, v152, v153
    v_cvt_pk_bf16_f32 v139, v154, v155
    v_cvt_pk_bf16_f32 v142, v156, v157
    v_cvt_pk_bf16_f32 v143, v158, v159
    v_pk_max_i16 v138, v138, 0
    v_pk_max_i16 v139, v139, 0
    v_pk_max_i16 v142, v142, 0
    v_pk_max_i16 v143, v143, 0
    v_permlane16_swap_b32 v136, v138
    v_permlane16_swap_b32 v137, v139
    v_permlane16_swap_b32 v140, v142
    v_permlane16_swap_b32 v141, v143
    s_load_dwordx2 s[50:51], s[0:1], 72
    s_load_dwordx2 s[48:49], s[0:1], 80
    v_and_b32 v8, 15, v1
    v_lshlrev_b32 v8, 4, v8
    v_and_b32 v10, 16, v1
    v_and_b32 v11, 32, v1
    v_lshl_add_u32 v9, v11, 3, v8
    v_lshl_add_u32 v8, v10, 5, v9
    v_lshlrev_b32 v10, 7, v10
    s_lshl_b32 s15, s13, 13
    s_lshl_b32 s16, s14, 9
    s_add_u32 s16, s16, s15
    s_add_u32 s16, s16, 99328
    v_add3_u32 v9, v9, v10, s16
    v_add_u32 v8, s15, v8
    s_cmp_lg_u32 s14, 0
    s_mov_b32 s16, 98304
    s_cselect_b32 s16, 0, s16
    v_add_u32 v10, s16, v8
    s_mov_b32 s16, 66560
    s_cselect_b32 s16, 1024, s16
    v_add_u32 v11, s16, v8
    s_mov_b32 s16, 65536
    s_cselect_b32 s16, 262144, s16
    v_add_u32 v12, s16, v8
    ds_write_b128 v12, v[128:131] offset:0
    v_lshlrev_b32 v182, 4, v1
    v_add_u32 v176, s15, v182
    ds_write_b128 v12, v[132:135] offset:2048
    v_lshrrev_b32 v184, 2, v1
    v_and_b32 v184, 3, v184
    ds_write_b128 v12, v[136:139] offset:4096
    v_lshrrev_b32 v185, 4, v1
    v_lshl_add_u32 v184, v185, 3, v184
    ds_write_b128 v12, v[140:143] offset:6144
    v_lshrrev_b32 v186, 3, v1
    v_and_b32 v186, 3, v186
    ds_write_b128 v11, v[96:99] offset:0
    v_lshlrev_b32 v186, 5, v186
    v_lshl_add_u32 v184, v184, 7, v186
    ds_write_b128 v11, v[100:103] offset:2048
    v_and_b32 v186, 3, v1
    v_lshl_add_u32 v177, v186, 3, v184
    ds_write_b128 v11, v[104:107] offset:4096
    s_lshl_b32 s16, s14, 6
    v_xor_b32 v177, s16, v177
    ds_write_b128 v11, v[108:111] offset:6144
    v_add_u32 v177, 16384, v177
    v_xor_b32 v180, 32, v177
    s_waitcnt vmcnt(0)
    s_barrier
    ds_write_b128 v10, v[64:67] offset:0
    v_add_u32 v178, 65536, v176
    v_add_u32 v179, 65536, v177
    v_add_u32 v181, 65536, v180
    ds_write_b128 v10, v[68:71] offset:2048
    v_mov_b32 v183, 0
    v_mov_b32 v192, v128
    v_mov_b32 v193, v129
    ds_write_b128 v10, v[72:75] offset:4096
    v_mov_b32 v194, v130
    v_mov_b32 v195, v131
    v_mov_b32 v196, v132
    ds_write_b128 v10, v[76:79] offset:6144
    v_mov_b32 v197, v133
    v_mov_b32 v198, v134
    v_mov_b32 v199, v135
    ds_write_b128 v9, v[160:163] offset:0
    v_mov_b32 v200, v136
    v_mov_b32 v201, v137
    v_mov_b32 v202, v138
    ds_write_b128 v9, v[168:171] offset:4096
    v_mov_b32 v203, v139
    v_mov_b32 v204, v140
    v_mov_b32 v205, v141
    v_mov_b32 v206, v142
    v_mov_b32 v207, v143
    s_mov_b32 s64, s20
    s_mov_b32 s65, s21
    s_mov_b32 s66, s22
    s_mov_b32 s67, 0x20000
    s_mov_b32 s68, s55
    s_mov_b32 s17, 65536
    s_waitcnt lgkmcnt(0)
    s_barrier
    ds_read_b64_tr_b16 v[104:105], v179 offset:0
    ds_read_b64_tr_b16 v[106:107], v179 offset:512
    ds_read_b64_tr_b16 v[108:109], v181 offset:0
    ds_read_b64_tr_b16 v[110:111], v181 offset:512
    ds_read_b128 v[72:75], v178 offset:0
    ds_read_b128 v[76:79], v178 offset:2048
    ds_read_b128 v[80:83], v178 offset:4096
    ds_read_b128 v[84:87], v178 offset:6144
    ds_read_b64_tr_b16 v[120:121], v179 offset:8192
    ds_read_b64_tr_b16 v[122:123], v179 offset:8704
    ds_read_b64_tr_b16 v[124:125], v181 offset:8192
    ds_read_b64_tr_b16 v[126:127], v181 offset:8704
    s_mov_b32 s9, s11
    s_lshr_b32 s8, s9, 3
    s_and_b32 s11, s9, 7
    s_lshl_b32 s11, s11, 1
    s_add_u32 s11, s11, s8
    s_lshl_b32 s15, s10, 1
    s_add_u32 s15, s15, s13
    s_lshl_b32 s16, s15, 18
    s_add_u32 s16, s16, 75497472
    s_lshl_b32 s19, s15, 8
    s_add_u32 s19, s19, 28835840
    s_lshl_b32 s54, s2, 2
    s_add_u32 s54, s54, s12
    s_xor_b32 s55, s54, 16
    s_lshl_b32 s56, s54, 12
    s_lshl_b32 s57, s55, 12
    s_lshl_b32 s54, s54, 7
    s_lshl_b32 s55, s55, 7
    s_add_u32 s54, s54, 65536
    s_add_u32 s55, s55, 65536
    s_add_u32 s20, s4, s16
    s_addc_u32 s21, s5, 0
    s_mov_b32 s22, 262144
    s_mov_b32 s23, 0x20000
    s_add_u32 s44, s4, s19
    s_addc_u32 s45, s5, 0
    s_mov_b32 s46, 256
    s_mov_b32 s47, 0x20000
    s_add_u32 s19, s19, 262144
    s_add_u32 s24, s4, s19
    s_addc_u32 s25, s5, 0
    s_mov_b32 s26, 256
    s_mov_b32 s27, 0x20000
    s_mov_b32 s28, s50
    s_mov_b32 s29, s51
    s_mov_b32 s30, 2048
    s_mov_b32 s31, 0x20000
    s_mov_b32 s32, s48
    s_mov_b32 s33, s49
    s_mov_b32 s34, 4194304
    s_mov_b32 s35, 0x20000
    s_add_u32 s40, s4, 30408704
    s_addc_u32 s41, s5, 0
    s_mov_b32 s42, 4194304
    s_mov_b32 s43, 0x20000
    s_lshl_b32 s16, s11, 1
    s_add_u32 s16, s16, s14
    s_lshl_b32 s19, s16, 11
    v_cmp_lt_u32 vcc, 383, v182
    v_mov_b32 v226, v182
    v_add_u32 v227, 128, v226
    v_cndmask_b32 v226, v226, v227, vcc
    buffer_load_dwordx4 v[136:139], v226, s[20:23], s19 offen sc1
    s_add_u32 s19, s19, 65536
    buffer_load_dwordx4 v[140:143], v226, s[20:23], s19 offen sc1
    s_add_u32 s19, s19, 65536
    buffer_load_dwordx4 v[144:147], v226, s[20:23], s19 offen sc1
    s_add_u32 s19, s19, 65536
    buffer_load_dwordx4 v[148:151], v226, s[20:23], s19 offen sc1
    v_and_b32 v224, 15, v1
    v_lshlrev_b32 v224, 2, v224
    buffer_load_dword v152, v224, s[24:27], 0 offen offset:0 sc1
    buffer_load_dword v160, v224, s[44:47], 0 offen offset:0 sc1
    buffer_load_dword v153, v224, s[24:27], 0 offen offset:64 sc1
    buffer_load_dword v161, v224, s[44:47], 0 offen offset:64 sc1
    buffer_load_dword v154, v224, s[24:27], 0 offen offset:128 sc1
    buffer_load_dword v162, v224, s[44:47], 0 offen offset:128 sc1
    buffer_load_dword v155, v224, s[24:27], 0 offen offset:192 sc1
    buffer_load_dword v163, v224, s[44:47], 0 offen offset:192 sc1
    v_lshrrev_b32 v225, 4, v1
    v_lshlrev_b32 v225, 3, v225
    s_lshl_b32 s19, s16, 6
    buffer_load_dwordx2 v[156:157], v225, s[28:31], s19 offen
    buffer_load_dwordx2 v[158:159], v225, s[28:31], s19 offen offset:32
    s_waitcnt lgkmcnt(0)
    v_mfma_f32_16x16x32_bf16 v[8:11], v[104:107], v[72:75], 0
    ds_read_b64_tr_b16 v[112:113], v179 offset:4096
    v_mfma_f32_16x16x32_bf16 v[12:15], v[104:107], v[76:79], 0
    ds_read_b64_tr_b16 v[114:115], v179 offset:4608
    v_mfma_f32_16x16x32_bf16 v[16:19], v[104:107], v[80:83], 0
    ds_read_b64_tr_b16 v[116:117], v181 offset:4096
    v_mfma_f32_16x16x32_bf16 v[20:23], v[104:107], v[84:87], 0
    ds_read_b64_tr_b16 v[118:119], v181 offset:4608
    v_mfma_f32_16x16x32_bf16 v[36:39], v[108:111], v[84:87], 0
    ds_read_b128 v[88:91], v178 offset:1024
    v_mfma_f32_16x16x32_bf16 v[32:35], v[108:111], v[80:83], 0
    ds_read_b128 v[92:95], v178 offset:3072
    v_mfma_f32_16x16x32_bf16 v[28:31], v[108:111], v[76:79], 0
    ds_read_b128 v[96:99], v178 offset:5120
    v_mfma_f32_16x16x32_bf16 v[24:27], v[108:111], v[72:75], 0
    ds_read_b128 v[100:103], v178 offset:7168
    v_mfma_f32_16x16x32_bf16 v[40:43], v[120:123], v[72:75], 0
    ds_read_b64_tr_b16 v[128:129], v179 offset:12288
    v_mfma_f32_16x16x32_bf16 v[44:47], v[120:123], v[76:79], 0
    ds_read_b64_tr_b16 v[130:131], v179 offset:12800
    v_mfma_f32_16x16x32_bf16 v[48:51], v[120:123], v[80:83], 0
    ds_read_b64_tr_b16 v[132:133], v181 offset:12288
    v_mfma_f32_16x16x32_bf16 v[52:55], v[120:123], v[84:87], 0
    ds_read_b64_tr_b16 v[134:135], v181 offset:12800
    v_mfma_f32_16x16x32_bf16 v[68:71], v[124:127], v[84:87], 0
    s_add_u32 s17, s17, 32768
    s_cmp_eq_u32 s17, 131072
    v_mfma_f32_16x16x32_bf16 v[64:67], v[124:127], v[80:83], 0
    s_cselect_b32 s17, 0, s17
    v_add_u32 v178, s17, v176
    v_mfma_f32_16x16x32_bf16 v[60:63], v[124:127], v[76:79], 0
    v_add_u32 v179, s17, v177
    v_mfma_f32_16x16x32_bf16 v[56:59], v[124:127], v[72:75], 0
    v_add_u32 v181, s17, v180
    buffer_store_dwordx4 v[192:195], v7, s[64:67], s68 offen sc1
    s_add_u32 s68, s68, 172032
    s_waitcnt lgkmcnt(0)
    s_barrier
    v_mfma_f32_16x16x32_bf16 v[8:11], v[112:115], v[88:91], v[8:11]
    ds_read_b64_tr_b16 v[104:105], v179 offset:0
    v_mfma_f32_16x16x32_bf16 v[12:15], v[112:115], v[92:95], v[12:15]
    ds_read_b64_tr_b16 v[106:107], v179 offset:512
    v_mfma_f32_16x16x32_bf16 v[16:19], v[112:115], v[96:99], v[16:19]
    ds_read_b64_tr_b16 v[108:109], v181 offset:0
    v_mfma_f32_16x16x32_bf16 v[20:23], v[112:115], v[100:103], v[20:23]
    ds_read_b64_tr_b16 v[110:111], v181 offset:512
    v_mfma_f32_16x16x32_bf16 v[36:39], v[116:119], v[100:103], v[36:39]
    ds_read_b128 v[72:75], v178 offset:0
    v_mfma_f32_16x16x32_bf16 v[32:35], v[116:119], v[96:99], v[32:35]
    ds_read_b128 v[76:79], v178 offset:2048
    v_mfma_f32_16x16x32_bf16 v[28:31], v[116:119], v[92:95], v[28:31]
    ds_read_b128 v[80:83], v178 offset:4096
    v_mfma_f32_16x16x32_bf16 v[24:27], v[116:119], v[88:91], v[24:27]
    ds_read_b128 v[84:87], v178 offset:6144
    v_mfma_f32_16x16x32_bf16 v[40:43], v[128:131], v[88:91], v[40:43]
    ds_read_b64_tr_b16 v[120:121], v179 offset:8192
    v_mfma_f32_16x16x32_bf16 v[44:47], v[128:131], v[92:95], v[44:47]
    ds_read_b64_tr_b16 v[122:123], v179 offset:8704
    v_mfma_f32_16x16x32_bf16 v[48:51], v[128:131], v[96:99], v[48:51]
    ds_read_b64_tr_b16 v[124:125], v181 offset:8192
    v_mfma_f32_16x16x32_bf16 v[52:55], v[128:131], v[100:103], v[52:55]
    ds_read_b64_tr_b16 v[126:127], v181 offset:8704
    v_mfma_f32_16x16x32_bf16 v[68:71], v[132:135], v[100:103], v[68:71]
    buffer_store_dwordx4 v[196:199], v7, s[64:67], s68 offen sc1
    s_add_u32 s68, s68, 172032
    v_mfma_f32_16x16x32_bf16 v[64:67], v[132:135], v[96:99], v[64:67]
    v_mfma_f32_16x16x32_bf16 v[60:63], v[132:135], v[92:95], v[60:63]
    v_mfma_f32_16x16x32_bf16 v[56:59], v[132:135], v[88:91], v[56:59]
    s_waitcnt lgkmcnt(0)
    v_mfma_f32_16x16x32_bf16 v[8:11], v[104:107], v[72:75], v[8:11]
    ds_read_b64_tr_b16 v[112:113], v179 offset:4096
    v_mfma_f32_16x16x32_bf16 v[12:15], v[104:107], v[76:79], v[12:15]
    ds_read_b64_tr_b16 v[114:115], v179 offset:4608
    v_mfma_f32_16x16x32_bf16 v[16:19], v[104:107], v[80:83], v[16:19]
    ds_read_b64_tr_b16 v[116:117], v181 offset:4096
    v_mfma_f32_16x16x32_bf16 v[20:23], v[104:107], v[84:87], v[20:23]
    ds_read_b64_tr_b16 v[118:119], v181 offset:4608
    v_mfma_f32_16x16x32_bf16 v[36:39], v[108:111], v[84:87], v[36:39]
    ds_read_b128 v[88:91], v178 offset:1024
    v_mfma_f32_16x16x32_bf16 v[32:35], v[108:111], v[80:83], v[32:35]
    ds_read_b128 v[92:95], v178 offset:3072
    v_mfma_f32_16x16x32_bf16 v[28:31], v[108:111], v[76:79], v[28:31]
    ds_read_b128 v[96:99], v178 offset:5120
    v_mfma_f32_16x16x32_bf16 v[24:27], v[108:111], v[72:75], v[24:27]
    ds_read_b128 v[100:103], v178 offset:7168
    v_mfma_f32_16x16x32_bf16 v[40:43], v[120:123], v[72:75], v[40:43]
    ds_read_b64_tr_b16 v[128:129], v179 offset:12288
    v_mfma_f32_16x16x32_bf16 v[44:47], v[120:123], v[76:79], v[44:47]
    ds_read_b64_tr_b16 v[130:131], v179 offset:12800
    v_mfma_f32_16x16x32_bf16 v[48:51], v[120:123], v[80:83], v[48:51]
    ds_read_b64_tr_b16 v[132:133], v181 offset:12288
    v_mfma_f32_16x16x32_bf16 v[52:55], v[120:123], v[84:87], v[52:55]
    ds_read_b64_tr_b16 v[134:135], v181 offset:12800
    v_mfma_f32_16x16x32_bf16 v[68:71], v[124:127], v[84:87], v[68:71]
    s_add_u32 s17, s17, 32768
    s_cmp_eq_u32 s17, 131072
    v_mfma_f32_16x16x32_bf16 v[64:67], v[124:127], v[80:83], v[64:67]
    s_cselect_b32 s17, 0, s17
    v_add_u32 v178, s17, v176
    v_mfma_f32_16x16x32_bf16 v[60:63], v[124:127], v[76:79], v[60:63]
    v_add_u32 v179, s17, v177
    v_mfma_f32_16x16x32_bf16 v[56:59], v[124:127], v[72:75], v[56:59]
    v_add_u32 v181, s17, v180
    s_waitcnt lgkmcnt(0)
    s_barrier
    v_mfma_f32_16x16x32_bf16 v[8:11], v[112:115], v[88:91], v[8:11]
    ds_read_b64_tr_b16 v[104:105], v179 offset:0
    v_mfma_f32_16x16x32_bf16 v[12:15], v[112:115], v[92:95], v[12:15]
    ds_read_b64_tr_b16 v[106:107], v179 offset:512
    v_mfma_f32_16x16x32_bf16 v[16:19], v[112:115], v[96:99], v[16:19]
    ds_read_b64_tr_b16 v[108:109], v181 offset:0
    v_mfma_f32_16x16x32_bf16 v[20:23], v[112:115], v[100:103], v[20:23]
    ds_read_b64_tr_b16 v[110:111], v181 offset:512
    v_mfma_f32_16x16x32_bf16 v[36:39], v[116:119], v[100:103], v[36:39]
    ds_read_b128 v[72:75], v178 offset:0
    v_mfma_f32_16x16x32_bf16 v[32:35], v[116:119], v[96:99], v[32:35]
    ds_read_b128 v[76:79], v178 offset:2048
    v_mfma_f32_16x16x32_bf16 v[28:31], v[116:119], v[92:95], v[28:31]
    ds_read_b128 v[80:83], v178 offset:4096
    v_mfma_f32_16x16x32_bf16 v[24:27], v[116:119], v[88:91], v[24:27]
    ds_read_b128 v[84:87], v178 offset:6144
    v_mfma_f32_16x16x32_bf16 v[40:43], v[128:131], v[88:91], v[40:43]
    ds_read_b64_tr_b16 v[120:121], v179 offset:8192
    v_mfma_f32_16x16x32_bf16 v[44:47], v[128:131], v[92:95], v[44:47]
    ds_read_b64_tr_b16 v[122:123], v179 offset:8704
    v_mfma_f32_16x16x32_bf16 v[48:51], v[128:131], v[96:99], v[48:51]
    ds_read_b64_tr_b16 v[124:125], v181 offset:8192
    v_mfma_f32_16x16x32_bf16 v[52:55], v[128:131], v[100:103], v[52:55]
    ds_read_b64_tr_b16 v[126:127], v181 offset:8704
    v_mfma_f32_16x16x32_bf16 v[68:71], v[132:135], v[100:103], v[68:71]
    buffer_store_dwordx4 v[200:203], v7, s[64:67], s68 offen sc1
    s_add_u32 s68, s68, 172032
    v_mfma_f32_16x16x32_bf16 v[64:67], v[132:135], v[96:99], v[64:67]
    v_mfma_f32_16x16x32_bf16 v[60:63], v[132:135], v[92:95], v[60:63]
    v_mfma_f32_16x16x32_bf16 v[56:59], v[132:135], v[88:91], v[56:59]
    s_waitcnt lgkmcnt(0)
    v_mfma_f32_16x16x32_bf16 v[8:11], v[104:107], v[72:75], v[8:11]
    ds_read_b64_tr_b16 v[112:113], v179 offset:4096
    v_mfma_f32_16x16x32_bf16 v[12:15], v[104:107], v[76:79], v[12:15]
    ds_read_b64_tr_b16 v[114:115], v179 offset:4608
    v_mfma_f32_16x16x32_bf16 v[16:19], v[104:107], v[80:83], v[16:19]
    ds_read_b64_tr_b16 v[116:117], v181 offset:4096
    v_mfma_f32_16x16x32_bf16 v[20:23], v[104:107], v[84:87], v[20:23]
    ds_read_b64_tr_b16 v[118:119], v181 offset:4608
    v_mfma_f32_16x16x32_bf16 v[36:39], v[108:111], v[84:87], v[36:39]
    ds_read_b128 v[88:91], v178 offset:1024
    v_mfma_f32_16x16x32_bf16 v[32:35], v[108:111], v[80:83], v[32:35]
    ds_read_b128 v[92:95], v178 offset:3072
    v_mfma_f32_16x16x32_bf16 v[28:31], v[108:111], v[76:79], v[28:31]
    ds_read_b128 v[96:99], v178 offset:5120
    v_mfma_f32_16x16x32_bf16 v[24:27], v[108:111], v[72:75], v[24:27]
    ds_read_b128 v[100:103], v178 offset:7168
    v_mfma_f32_16x16x32_bf16 v[40:43], v[120:123], v[72:75], v[40:43]
    ds_read_b64_tr_b16 v[128:129], v179 offset:12288
    v_mfma_f32_16x16x32_bf16 v[44:47], v[120:123], v[76:79], v[44:47]
    ds_read_b64_tr_b16 v[130:131], v179 offset:12800
    v_mfma_f32_16x16x32_bf16 v[48:51], v[120:123], v[80:83], v[48:51]
    ds_read_b64_tr_b16 v[132:133], v181 offset:12288
    v_mfma_f32_16x16x32_bf16 v[52:55], v[120:123], v[84:87], v[52:55]
    ds_read_b64_tr_b16 v[134:135], v181 offset:12800
    v_mfma_f32_16x16x32_bf16 v[68:71], v[124:127], v[84:87], v[68:71]
    s_add_u32 s17, s17, 32768
    s_cmp_eq_u32 s17, 131072
    v_mfma_f32_16x16x32_bf16 v[64:67], v[124:127], v[80:83], v[64:67]
    s_cselect_b32 s17, 0, s17
    v_add_u32 v178, s17, v176
    v_mfma_f32_16x16x32_bf16 v[60:63], v[124:127], v[76:79], v[60:63]
    v_add_u32 v179, s17, v177
    v_mfma_f32_16x16x32_bf16 v[56:59], v[124:127], v[72:75], v[56:59]
    v_add_u32 v181, s17, v180
    s_waitcnt lgkmcnt(0)
    s_barrier
    v_mfma_f32_16x16x32_bf16 v[8:11], v[112:115], v[88:91], v[8:11]
    ds_read_b64_tr_b16 v[104:105], v179 offset:0
    v_mfma_f32_16x16x32_bf16 v[12:15], v[112:115], v[92:95], v[12:15]
    ds_read_b64_tr_b16 v[106:107], v179 offset:512
    v_mfma_f32_16x16x32_bf16 v[16:19], v[112:115], v[96:99], v[16:19]
    ds_read_b64_tr_b16 v[108:109], v181 offset:0
    v_mfma_f32_16x16x32_bf16 v[20:23], v[112:115], v[100:103], v[20:23]
    ds_read_b64_tr_b16 v[110:111], v181 offset:512
    v_mfma_f32_16x16x32_bf16 v[36:39], v[116:119], v[100:103], v[36:39]
    ds_read_b128 v[72:75], v178 offset:0
    v_mfma_f32_16x16x32_bf16 v[32:35], v[116:119], v[96:99], v[32:35]
    ds_read_b128 v[76:79], v178 offset:2048
    v_mfma_f32_16x16x32_bf16 v[28:31], v[116:119], v[92:95], v[28:31]
    ds_read_b128 v[80:83], v178 offset:4096
    v_mfma_f32_16x16x32_bf16 v[24:27], v[116:119], v[88:91], v[24:27]
    ds_read_b128 v[84:87], v178 offset:6144
    v_mfma_f32_16x16x32_bf16 v[40:43], v[128:131], v[88:91], v[40:43]
    ds_read_b64_tr_b16 v[120:121], v179 offset:8192
    v_mfma_f32_16x16x32_bf16 v[44:47], v[128:131], v[92:95], v[44:47]
    ds_read_b64_tr_b16 v[122:123], v179 offset:8704
    v_mfma_f32_16x16x32_bf16 v[48:51], v[128:131], v[96:99], v[48:51]
    ds_read_b64_tr_b16 v[124:125], v181 offset:8192
    v_mfma_f32_16x16x32_bf16 v[52:55], v[128:131], v[100:103], v[52:55]
    ds_read_b64_tr_b16 v[126:127], v181 offset:8704
    v_mfma_f32_16x16x32_bf16 v[68:71], v[132:135], v[100:103], v[68:71]
    buffer_store_dwordx4 v[204:207], v7, s[64:67], s68 offen sc1
    s_add_u32 s68, s68, 172032
    v_mfma_f32_16x16x32_bf16 v[64:67], v[132:135], v[96:99], v[64:67]
    v_mfma_f32_16x16x32_bf16 v[60:63], v[132:135], v[92:95], v[60:63]
    v_mfma_f32_16x16x32_bf16 v[56:59], v[132:135], v[88:91], v[56:59]
    s_waitcnt lgkmcnt(0)
    v_mfma_f32_16x16x32_bf16 v[8:11], v[104:107], v[72:75], v[8:11]
    ds_read_b64_tr_b16 v[112:113], v179 offset:4096
    v_mfma_f32_16x16x32_bf16 v[12:15], v[104:107], v[76:79], v[12:15]
    ds_read_b64_tr_b16 v[114:115], v179 offset:4608
    v_mfma_f32_16x16x32_bf16 v[16:19], v[104:107], v[80:83], v[16:19]
    ds_read_b64_tr_b16 v[116:117], v181 offset:4096
    v_mfma_f32_16x16x32_bf16 v[20:23], v[104:107], v[84:87], v[20:23]
    ds_read_b64_tr_b16 v[118:119], v181 offset:4608
    v_mfma_f32_16x16x32_bf16 v[36:39], v[108:111], v[84:87], v[36:39]
    ds_read_b128 v[88:91], v178 offset:1024
    v_mfma_f32_16x16x32_bf16 v[32:35], v[108:111], v[80:83], v[32:35]
    ds_read_b128 v[92:95], v178 offset:3072
    v_mfma_f32_16x16x32_bf16 v[28:31], v[108:111], v[76:79], v[28:31]
    ds_read_b128 v[96:99], v178 offset:5120
    v_mfma_f32_16x16x32_bf16 v[24:27], v[108:111], v[72:75], v[24:27]
    ds_read_b128 v[100:103], v178 offset:7168
    v_mfma_f32_16x16x32_bf16 v[40:43], v[120:123], v[72:75], v[40:43]
    ds_read_b64_tr_b16 v[128:129], v179 offset:12288
    v_mfma_f32_16x16x32_bf16 v[44:47], v[120:123], v[76:79], v[44:47]
    ds_read_b64_tr_b16 v[130:131], v179 offset:12800
    v_mfma_f32_16x16x32_bf16 v[48:51], v[120:123], v[80:83], v[48:51]
    ds_read_b64_tr_b16 v[132:133], v181 offset:12288
    v_mfma_f32_16x16x32_bf16 v[52:55], v[120:123], v[84:87], v[52:55]
    ds_read_b64_tr_b16 v[134:135], v181 offset:12800
    v_mfma_f32_16x16x32_bf16 v[68:71], v[124:127], v[84:87], v[68:71]
    s_add_u32 s17, s17, 32768
    s_cmp_eq_u32 s17, 131072
    v_mfma_f32_16x16x32_bf16 v[64:67], v[124:127], v[80:83], v[64:67]
    s_cselect_b32 s17, 0, s17
    v_add_u32 v178, s17, v176
    v_mfma_f32_16x16x32_bf16 v[60:63], v[124:127], v[76:79], v[60:63]
    v_add_u32 v179, s17, v177
    v_mfma_f32_16x16x32_bf16 v[56:59], v[124:127], v[72:75], v[56:59]
    v_add_u32 v181, s17, v180
    s_waitcnt lgkmcnt(0)
    s_mov_b32 s18, 4
.p2align 6
m_kernel_g2loop:
    s_barrier
    v_mfma_f32_16x16x32_bf16 v[8:11], v[112:115], v[88:91], v[8:11]
    ds_read_b64_tr_b16 v[104:105], v179 offset:0
    v_mfma_f32_16x16x32_bf16 v[12:15], v[112:115], v[92:95], v[12:15]
    ds_read_b64_tr_b16 v[106:107], v179 offset:512
    v_mfma_f32_16x16x32_bf16 v[16:19], v[112:115], v[96:99], v[16:19]
    ds_read_b64_tr_b16 v[108:109], v181 offset:0
    v_mfma_f32_16x16x32_bf16 v[20:23], v[112:115], v[100:103], v[20:23]
    ds_read_b64_tr_b16 v[110:111], v181 offset:512
    v_mfma_f32_16x16x32_bf16 v[36:39], v[116:119], v[100:103], v[36:39]
    ds_read_b128 v[72:75], v178 offset:0
    v_mfma_f32_16x16x32_bf16 v[32:35], v[116:119], v[96:99], v[32:35]
    ds_read_b128 v[76:79], v178 offset:2048
    v_mfma_f32_16x16x32_bf16 v[28:31], v[116:119], v[92:95], v[28:31]
    ds_read_b128 v[80:83], v178 offset:4096
    v_mfma_f32_16x16x32_bf16 v[24:27], v[116:119], v[88:91], v[24:27]
    ds_read_b128 v[84:87], v178 offset:6144
    v_mfma_f32_16x16x32_bf16 v[40:43], v[128:131], v[88:91], v[40:43]
    ds_read_b64_tr_b16 v[120:121], v179 offset:8192
    v_mfma_f32_16x16x32_bf16 v[44:47], v[128:131], v[92:95], v[44:47]
    ds_read_b64_tr_b16 v[122:123], v179 offset:8704
    v_mfma_f32_16x16x32_bf16 v[48:51], v[128:131], v[96:99], v[48:51]
    ds_read_b64_tr_b16 v[124:125], v181 offset:8192
    v_mfma_f32_16x16x32_bf16 v[52:55], v[128:131], v[100:103], v[52:55]
    ds_read_b64_tr_b16 v[126:127], v181 offset:8704
    v_mfma_f32_16x16x32_bf16 v[68:71], v[132:135], v[100:103], v[68:71]
    s_waitcnt vmcnt(0)
    v_mfma_f32_16x16x32_bf16 v[64:67], v[132:135], v[96:99], v[64:67]
    v_mfma_f32_16x16x32_bf16 v[60:63], v[132:135], v[92:95], v[60:63]
    v_mfma_f32_16x16x32_bf16 v[56:59], v[132:135], v[88:91], v[56:59]
    s_waitcnt lgkmcnt(0)
    v_mfma_f32_16x16x32_bf16 v[8:11], v[104:107], v[72:75], v[8:11]
    ds_read_b64_tr_b16 v[112:113], v179 offset:4096
    v_mfma_f32_16x16x32_bf16 v[12:15], v[104:107], v[76:79], v[12:15]
    ds_read_b64_tr_b16 v[114:115], v179 offset:4608
    v_mfma_f32_16x16x32_bf16 v[16:19], v[104:107], v[80:83], v[16:19]
    ds_read_b64_tr_b16 v[116:117], v181 offset:4096
    v_mfma_f32_16x16x32_bf16 v[20:23], v[104:107], v[84:87], v[20:23]
    ds_read_b64_tr_b16 v[118:119], v181 offset:4608
    v_mfma_f32_16x16x32_bf16 v[36:39], v[108:111], v[84:87], v[36:39]
    ds_read_b128 v[88:91], v178 offset:1024
    v_mfma_f32_16x16x32_bf16 v[32:35], v[108:111], v[80:83], v[32:35]
    ds_read_b128 v[92:95], v178 offset:3072
    v_mfma_f32_16x16x32_bf16 v[28:31], v[108:111], v[76:79], v[28:31]
    ds_read_b128 v[96:99], v178 offset:5120
    v_mfma_f32_16x16x32_bf16 v[24:27], v[108:111], v[72:75], v[24:27]
    ds_read_b128 v[100:103], v178 offset:7168
    v_mfma_f32_16x16x32_bf16 v[40:43], v[120:123], v[72:75], v[40:43]
    ds_read_b64_tr_b16 v[128:129], v179 offset:12288
    v_mfma_f32_16x16x32_bf16 v[44:47], v[120:123], v[76:79], v[44:47]
    ds_read_b64_tr_b16 v[130:131], v179 offset:12800
    v_mfma_f32_16x16x32_bf16 v[48:51], v[120:123], v[80:83], v[48:51]
    ds_read_b64_tr_b16 v[132:133], v181 offset:12288
    v_mfma_f32_16x16x32_bf16 v[52:55], v[120:123], v[84:87], v[52:55]
    ds_read_b64_tr_b16 v[134:135], v181 offset:12800
    v_mfma_f32_16x16x32_bf16 v[68:71], v[124:127], v[84:87], v[68:71]
    s_add_u32 s17, s17, 32768
    s_cmp_eq_u32 s17, 131072
    v_mfma_f32_16x16x32_bf16 v[64:67], v[124:127], v[80:83], v[64:67]
    s_cselect_b32 s17, 0, s17
    v_add_u32 v178, s17, v176
    v_mfma_f32_16x16x32_bf16 v[60:63], v[124:127], v[76:79], v[60:63]
    v_add_u32 v179, s17, v177
    v_mfma_f32_16x16x32_bf16 v[56:59], v[124:127], v[72:75], v[56:59]
    v_add_u32 v181, s17, v180
    s_add_u32 s18, s18, 1
    s_cmp_lt_u32 s18, 24
    s_waitcnt lgkmcnt(0)
    s_cbranch_scc1 m_kernel_g2loop
    s_mov_b32 s59, 0
    s_mov_b32 s58, 400000
    s_barrier
    v_mfma_f32_16x16x32_bf16 v[40:43], v[128:131], v[88:91], v[40:43]
    ds_read_b64_tr_b16 v[104:105], v179 offset:0
    v_mfma_f32_16x16x32_bf16 v[44:47], v[128:131], v[92:95], v[44:47]
    ds_read_b64_tr_b16 v[106:107], v179 offset:512
    v_mfma_f32_16x16x32_bf16 v[48:51], v[128:131], v[96:99], v[48:51]
    ds_read_b64_tr_b16 v[108:109], v181 offset:0
    v_mfma_f32_16x16x32_bf16 v[52:55], v[128:131], v[100:103], v[52:55]
    ds_read_b64_tr_b16 v[110:111], v181 offset:512
    v_mfma_f32_16x16x32_bf16 v[68:71], v[132:135], v[100:103], v[68:71]
    ds_read_b128 v[72:75], v178 offset:0
    v_mfma_f32_16x16x32_bf16 v[64:67], v[132:135], v[96:99], v[64:67]
    ds_read_b128 v[76:79], v178 offset:2048
    v_mfma_f32_16x16x32_bf16 v[60:63], v[132:135], v[92:95], v[60:63]
    ds_read_b128 v[80:83], v178 offset:4096
    v_mfma_f32_16x16x32_bf16 v[56:59], v[132:135], v[88:91], v[56:59]
    ds_read_b128 v[84:87], v178 offset:6144
    v_mfma_f32_16x16x32_bf16 v[8:11], v[112:115], v[88:91], v[8:11]
    v_mfma_f32_16x16x32_bf16 v[12:15], v[112:115], v[92:95], v[12:15]
    v_mfma_f32_16x16x32_bf16 v[16:19], v[112:115], v[96:99], v[16:19]
    v_mfma_f32_16x16x32_bf16 v[20:23], v[112:115], v[100:103], v[20:23]
    v_mfma_f32_16x16x32_bf16 v[36:39], v[116:119], v[100:103], v[36:39]
    v_mfma_f32_16x16x32_bf16 v[32:35], v[116:119], v[96:99], v[32:35]
    v_mfma_f32_16x16x32_bf16 v[28:31], v[116:119], v[92:95], v[28:31]
    v_mfma_f32_16x16x32_bf16 v[24:27], v[116:119], v[88:91], v[24:27]
    s_waitcnt lgkmcnt(0)
    v_cvt_pk_bf16_f32 v40, v40, v41
    v_cvt_pk_bf16_f32 v41, v42, v43
    v_cvt_pk_bf16_f32 v42, v44, v45
    v_cvt_pk_bf16_f32 v43, v46, v47
    buffer_store_dwordx4 v[40:43], v182, s[40:43], s56 offen offset:0 sc1
    v_cvt_pk_bf16_f32 v44, v48, v49
    v_cvt_pk_bf16_f32 v45, v50, v51
    v_cvt_pk_bf16_f32 v46, v52, v53
    v_cvt_pk_bf16_f32 v47, v54, v55
    buffer_store_dwordx4 v[44:47], v182, s[40:43], s56 offen offset:1024 sc1
    v_cvt_pk_bf16_f32 v48, v56, v57
    v_cvt_pk_bf16_f32 v49, v58, v59
    v_cvt_pk_bf16_f32 v50, v60, v61
    v_cvt_pk_bf16_f32 v51, v62, v63
    buffer_store_dwordx4 v[48:51], v182, s[40:43], s56 offen offset:2048 sc1
    v_cvt_pk_bf16_f32 v52, v64, v65
    v_cvt_pk_bf16_f32 v53, v66, v67
    v_cvt_pk_bf16_f32 v54, v68, v69
    v_cvt_pk_bf16_f32 v55, v70, v71
    buffer_store_dwordx4 v[52:55], v182, s[40:43], s56 offen offset:3072 sc1
    v_mfma_f32_16x16x32_bf16 v[8:11], v[104:107], v[72:75], v[8:11]
    ds_read_b64_tr_b16 v[112:113], v179 offset:4096
    ds_read_b64_tr_b16 v[114:115], v179 offset:4608
    v_mfma_f32_16x16x32_bf16 v[12:15], v[104:107], v[76:79], v[12:15]
    ds_read_b64_tr_b16 v[116:117], v181 offset:4096
    ds_read_b64_tr_b16 v[118:119], v181 offset:4608
    v_mfma_f32_16x16x32_bf16 v[16:19], v[104:107], v[80:83], v[16:19]
    ds_read_b128 v[88:91], v178 offset:1024
    ds_read_b128 v[92:95], v178 offset:3072
    v_mfma_f32_16x16x32_bf16 v[20:23], v[104:107], v[84:87], v[20:23]
    ds_read_b128 v[96:99], v178 offset:5120
    ds_read_b128 v[100:103], v178 offset:7168
    v_mfma_f32_16x16x32_bf16 v[36:39], v[108:111], v[84:87], v[36:39]
    s_add_u32 s17, s17, 32768
    s_cmp_eq_u32 s17, 131072
    v_mfma_f32_16x16x32_bf16 v[32:35], v[108:111], v[80:83], v[32:35]
    s_cselect_b32 s17, 0, s17
    v_add_u32 v178, s17, v176
    v_mfma_f32_16x16x32_bf16 v[28:31], v[108:111], v[76:79], v[28:31]
    v_add_u32 v179, s17, v177
    v_mfma_f32_16x16x32_bf16 v[24:27], v[108:111], v[72:75], v[24:27]
    v_add_u32 v181, s17, v180
    s_waitcnt lgkmcnt(0)
    s_barrier
    v_mfma_f32_16x16x32_bf16 v[8:11], v[112:115], v[88:91], v[8:11]
    ds_read_b64_tr_b16 v[104:105], v179 offset:0
    v_mfma_f32_16x16x32_bf16 v[12:15], v[112:115], v[92:95], v[12:15]
    ds_read_b64_tr_b16 v[106:107], v179 offset:512
    v_mfma_f32_16x16x32_bf16 v[16:19], v[112:115], v[96:99], v[16:19]
    ds_read_b64_tr_b16 v[108:109], v181 offset:0
    v_mfma_f32_16x16x32_bf16 v[20:23], v[112:115], v[100:103], v[20:23]
    ds_read_b64_tr_b16 v[110:111], v181 offset:512
    v_mfma_f32_16x16x32_bf16 v[36:39], v[116:119], v[100:103], v[36:39]
    ds_read_b128 v[72:75], v178 offset:0
    v_mfma_f32_16x16x32_bf16 v[32:35], v[116:119], v[96:99], v[32:35]
    ds_read_b128 v[76:79], v178 offset:2048
    v_mfma_f32_16x16x32_bf16 v[28:31], v[116:119], v[92:95], v[28:31]
    ds_read_b128 v[80:83], v178 offset:4096
    v_mfma_f32_16x16x32_bf16 v[24:27], v[116:119], v[88:91], v[24:27]
    ds_read_b128 v[84:87], v178 offset:6144
    s_waitcnt lgkmcnt(0)
    v_and_b32 v6, 15, v1
    v_lshrrev_b32 v7, 4, v1
    v_and_b32 v2, 1, v7
    v_lshrrev_b32 v7, 1, v7
    v_lshl_add_u32 v7, v2, 1, v7
    v_lshrrev_b32 v2, 1, v6
    v_xor_b32 v7, v7, v2
    v_and_b32 v7, 3, v7
    v_lshl_add_u32 v7, v6, 2, v7
    s_lshl_b32 s15, s12, 12
    s_add_u32 s15, s15, 136704
    v_lshl_add_u32 v4, v7, 4, s15
    v_lshrrev_b32 v6, 2, v1
    v_lshrrev_b32 v7, 3, v1
    v_xor_b32 v7, v7, v1
    v_and_b32 v7, 3, v7
    v_lshl_add_u32 v5, v1, 4, s15
    v_lshlrev_b32 v6, 15, v6
    v_lshl_add_u32 v6, v7, 4, v6
    s_lshl_b32 s19, s10, 11
    s_lshl_b32 s15, s13, 21
    s_add_u32 s19, s19, s15
    s_lshl_b32 s16, s16, 6
    s_add_u32 s19, s19, s16
    s_mov_b32 s60, 0x3f80
    s_mov_b32 s61, 0x3f800000
    v_lshlrev_b32 v184, 16, v156
    v_and_b32 v185, 0xffff0000, v156
    v_lshlrev_b32 v186, 16, v157
    v_and_b32 v187, 0xffff0000, v157
    v_lshlrev_b32 v188, 16, v158
    v_and_b32 v189, 0xffff0000, v158
    v_lshlrev_b32 v190, 16, v159
    v_and_b32 v191, 0xffff0000, v159
    v_mfma_f32_16x16x32_bf16 v[8:11], v[104:107], v[72:75], v[8:11]
    ds_read_b64_tr_b16 v[112:113], v179 offset:4096
    ds_read_b64_tr_b16 v[114:115], v179 offset:4608
    v_mfma_f32_16x16x32_bf16 v[12:15], v[104:107], v[76:79], v[12:15]
    ds_read_b64_tr_b16 v[116:117], v181 offset:4096
    ds_read_b64_tr_b16 v[118:119], v181 offset:4608
    v_mfma_f32_16x16x32_bf16 v[16:19], v[104:107], v[80:83], v[16:19]
    ds_read_b128 v[88:91], v178 offset:1024
    ds_read_b128 v[92:95], v178 offset:3072
    v_mfma_f32_16x16x32_bf16 v[20:23], v[104:107], v[84:87], v[20:23]
    ds_read_b128 v[96:99], v178 offset:5120
    ds_read_b128 v[100:103], v178 offset:7168
    v_mfma_f32_16x16x32_bf16 v[36:39], v[108:111], v[84:87], v[36:39]
    s_add_u32 s17, s17, 32768
    s_cmp_eq_u32 s17, 131072
    v_mfma_f32_16x16x32_bf16 v[32:35], v[108:111], v[80:83], v[32:35]
    s_cselect_b32 s17, 0, s17
    v_add_u32 v178, s17, v176
    v_mfma_f32_16x16x32_bf16 v[28:31], v[108:111], v[76:79], v[28:31]
    v_add_u32 v179, s17, v177
    v_mfma_f32_16x16x32_bf16 v[24:27], v[108:111], v[72:75], v[24:27]
    v_add_u32 v181, s17, v180
    s_waitcnt lgkmcnt(0)
    s_barrier
    s_waitcnt vmcnt(0)
    v_mov_b32 v224, 1
    buffer_store_dword v224, v183, s[36:39], s54 offen sc1
    v_mfma_f32_16x16x32_bf16 v[8:11], v[112:115], v[88:91], v[8:11]
    ds_read_b64_tr_b16 v[104:105], v179 offset:0
    v_mfma_f32_16x16x32_bf16 v[12:15], v[112:115], v[92:95], v[12:15]
    ds_read_b64_tr_b16 v[106:107], v179 offset:512
    v_mfma_f32_16x16x32_bf16 v[16:19], v[112:115], v[96:99], v[16:19]
    ds_read_b64_tr_b16 v[108:109], v181 offset:0
    v_mfma_f32_16x16x32_bf16 v[20:23], v[112:115], v[100:103], v[20:23]
    ds_read_b64_tr_b16 v[110:111], v181 offset:512
    v_mfma_f32_16x16x32_bf16 v[36:39], v[116:119], v[100:103], v[36:39]
    ds_read_b128 v[72:75], v178 offset:0
    v_mfma_f32_16x16x32_bf16 v[32:35], v[116:119], v[96:99], v[32:35]
    ds_read_b128 v[76:79], v178 offset:2048
    v_mfma_f32_16x16x32_bf16 v[28:31], v[116:119], v[92:95], v[28:31]
    ds_read_b128 v[80:83], v178 offset:4096
    v_mfma_f32_16x16x32_bf16 v[24:27], v[116:119], v[88:91], v[24:27]
    ds_read_b128 v[84:87], v178 offset:6144
    s_waitcnt lgkmcnt(0)
    v_lshlrev_b32 v192, 16, v136
    v_and_b32 v193, 0xffff0000, v136
    v_lshlrev_b32 v194, 16, v137
    v_and_b32 v195, 0xffff0000, v137
    v_pk_add_f32 v[192:193], v[192:193], v[184:185]
    v_pk_add_f32 v[194:195], v[194:195], v[186:187]
    v_add_f32 v192, v192, v160
    v_add_f32 v193, v193, v160
    v_add_f32 v194, v194, v160
    v_add_f32 v195, v195, v160
    v_lshlrev_b32 v208, 16, v138
    v_and_b32 v209, 0xffff0000, v138
    v_lshlrev_b32 v210, 16, v139
    v_and_b32 v211, 0xffff0000, v139
    v_pk_add_f32 v[208:209], v[208:209], v[188:189]
    v_pk_add_f32 v[210:211], v[210:211], v[190:191]
    v_add_f32 v208, v208, v160
    v_add_f32 v209, v209, v160
    v_add_f32 v210, v210, v160
    v_add_f32 v211, v211, v160
    v_mfma_f32_16x16x32_bf16 v[8:11], v[104:107], v[72:75], v[8:11]
    ds_read_b64_tr_b16 v[112:113], v179 offset:4096
    ds_read_b64_tr_b16 v[114:115], v179 offset:4608
    v_mfma_f32_16x16x32_bf16 v[12:15], v[104:107], v[76:79], v[12:15]
    ds_read_b64_tr_b16 v[116:117], v181 offset:4096
    ds_read_b64_tr_b16 v[118:119], v181 offset:4608
    v_mfma_f32_16x16x32_bf16 v[16:19], v[104:107], v[80:83], v[16:19]
    ds_read_b128 v[88:91], v178 offset:1024
    ds_read_b128 v[92:95], v178 offset:3072
    v_mfma_f32_16x16x32_bf16 v[20:23], v[104:107], v[84:87], v[20:23]
    ds_read_b128 v[96:99], v178 offset:5120
    ds_read_b128 v[100:103], v178 offset:7168
    v_mfma_f32_16x16x32_bf16 v[36:39], v[108:111], v[84:87], v[36:39]
    s_add_u32 s17, s17, 32768
    s_cmp_eq_u32 s17, 131072
    v_mfma_f32_16x16x32_bf16 v[32:35], v[108:111], v[80:83], v[32:35]
    s_cselect_b32 s17, 0, s17
    v_add_u32 v178, s17, v176
    v_mfma_f32_16x16x32_bf16 v[28:31], v[108:111], v[76:79], v[28:31]
    v_add_u32 v179, s17, v177
    v_mfma_f32_16x16x32_bf16 v[24:27], v[108:111], v[72:75], v[24:27]
    v_add_u32 v181, s17, v180
    s_waitcnt lgkmcnt(0)
    s_barrier
    v_mfma_f32_16x16x32_bf16 v[8:11], v[112:115], v[88:91], v[8:11]
    ds_read_b64_tr_b16 v[104:105], v179 offset:0
    v_mfma_f32_16x16x32_bf16 v[12:15], v[112:115], v[92:95], v[12:15]
    ds_read_b64_tr_b16 v[106:107], v179 offset:512
    v_mfma_f32_16x16x32_bf16 v[16:19], v[112:115], v[96:99], v[16:19]
    ds_read_b64_tr_b16 v[108:109], v181 offset:0
    v_mfma_f32_16x16x32_bf16 v[20:23], v[112:115], v[100:103], v[20:23]
    ds_read_b64_tr_b16 v[110:111], v181 offset:512
    v_mfma_f32_16x16x32_bf16 v[36:39], v[116:119], v[100:103], v[36:39]
    ds_read_b128 v[72:75], v178 offset:0
    v_mfma_f32_16x16x32_bf16 v[32:35], v[116:119], v[96:99], v[32:35]
    ds_read_b128 v[76:79], v178 offset:2048
    v_mfma_f32_16x16x32_bf16 v[28:31], v[116:119], v[92:95], v[28:31]
    ds_read_b128 v[80:83], v178 offset:4096
    v_mfma_f32_16x16x32_bf16 v[24:27], v[116:119], v[88:91], v[24:27]
    ds_read_b128 v[84:87], v178 offset:6144
    s_waitcnt lgkmcnt(0)
    v_lshlrev_b32 v196, 16, v140
    v_and_b32 v197, 0xffff0000, v140
    v_lshlrev_b32 v198, 16, v141
    v_and_b32 v199, 0xffff0000, v141
    v_pk_add_f32 v[196:197], v[196:197], v[184:185]
    v_pk_add_f32 v[198:199], v[198:199], v[186:187]
    v_add_f32 v196, v196, v161
    v_add_f32 v197, v197, v161
    v_add_f32 v198, v198, v161
    v_add_f32 v199, v199, v161
    v_lshlrev_b32 v212, 16, v142
    v_and_b32 v213, 0xffff0000, v142
    v_lshlrev_b32 v214, 16, v143
    v_and_b32 v215, 0xffff0000, v143
    v_pk_add_f32 v[212:213], v[212:213], v[188:189]
    v_pk_add_f32 v[214:215], v[214:215], v[190:191]
    v_add_f32 v212, v212, v161
    v_add_f32 v213, v213, v161
    v_add_f32 v214, v214, v161
    v_add_f32 v215, v215, v161
    v_mfma_f32_16x16x32_bf16 v[8:11], v[104:107], v[72:75], v[8:11]
    ds_read_b64_tr_b16 v[112:113], v179 offset:4096
    ds_read_b64_tr_b16 v[114:115], v179 offset:4608
    v_mfma_f32_16x16x32_bf16 v[12:15], v[104:107], v[76:79], v[12:15]
    ds_read_b64_tr_b16 v[116:117], v181 offset:4096
    ds_read_b64_tr_b16 v[118:119], v181 offset:4608
    v_mfma_f32_16x16x32_bf16 v[16:19], v[104:107], v[80:83], v[16:19]
    ds_read_b128 v[88:91], v178 offset:1024
    ds_read_b128 v[92:95], v178 offset:3072
    v_mfma_f32_16x16x32_bf16 v[20:23], v[104:107], v[84:87], v[20:23]
    ds_read_b128 v[96:99], v178 offset:5120
    ds_read_b128 v[100:103], v178 offset:7168
    v_mfma_f32_16x16x32_bf16 v[36:39], v[108:111], v[84:87], v[36:39]
    s_add_u32 s17, s17, 32768
    s_cmp_eq_u32 s17, 131072
    v_mfma_f32_16x16x32_bf16 v[32:35], v[108:111], v[80:83], v[32:35]
    s_cselect_b32 s17, 0, s17
    v_add_u32 v178, s17, v176
    v_mfma_f32_16x16x32_bf16 v[28:31], v[108:111], v[76:79], v[28:31]
    v_add_u32 v179, s17, v177
    v_mfma_f32_16x16x32_bf16 v[24:27], v[108:111], v[72:75], v[24:27]
    v_add_u32 v181, s17, v180
    s_waitcnt lgkmcnt(0)
    s_barrier
    buffer_load_dword v240, v183, s[36:39], s55 offen sc1
    v_mfma_f32_16x16x32_bf16 v[8:11], v[112:115], v[88:91], v[8:11]
    ds_read_b64_tr_b16 v[104:105], v179 offset:0
    v_mfma_f32_16x16x32_bf16 v[12:15], v[112:115], v[92:95], v[12:15]
    ds_read_b64_tr_b16 v[106:107], v179 offset:512
    v_mfma_f32_16x16x32_bf16 v[16:19], v[112:115], v[96:99], v[16:19]
    ds_read_b64_tr_b16 v[108:109], v181 offset:0
    v_mfma_f32_16x16x32_bf16 v[20:23], v[112:115], v[100:103], v[20:23]
    ds_read_b64_tr_b16 v[110:111], v181 offset:512
    v_mfma_f32_16x16x32_bf16 v[36:39], v[116:119], v[100:103], v[36:39]
    ds_read_b128 v[72:75], v178 offset:0
    v_mfma_f32_16x16x32_bf16 v[32:35], v[116:119], v[96:99], v[32:35]
    ds_read_b128 v[76:79], v178 offset:2048
    v_mfma_f32_16x16x32_bf16 v[28:31], v[116:119], v[92:95], v[28:31]
    ds_read_b128 v[80:83], v178 offset:4096
    v_mfma_f32_16x16x32_bf16 v[24:27], v[116:119], v[88:91], v[24:27]
    ds_read_b128 v[84:87], v178 offset:6144
    s_waitcnt lgkmcnt(0)
    v_lshlrev_b32 v200, 16, v144
    v_and_b32 v201, 0xffff0000, v144
    v_lshlrev_b32 v202, 16, v145
    v_and_b32 v203, 0xffff0000, v145
    v_pk_add_f32 v[200:201], v[200:201], v[184:185]
    v_pk_add_f32 v[202:203], v[202:203], v[186:187]
    v_add_f32 v200, v200, v162
    v_add_f32 v201, v201, v162
    v_add_f32 v202, v202, v162
    v_add_f32 v203, v203, v162
    v_lshlrev_b32 v216, 16, v146
    v_and_b32 v217, 0xffff0000, v146
    v_lshlrev_b32 v218, 16, v147
    v_and_b32 v219, 0xffff0000, v147
    v_pk_add_f32 v[216:217], v[216:217], v[188:189]
    v_pk_add_f32 v[218:219], v[218:219], v[190:191]
    v_add_f32 v216, v216, v162
    v_add_f32 v217, v217, v162
    v_add_f32 v218, v218, v162
    v_add_f32 v219, v219, v162
    v_mfma_f32_16x16x32_bf16 v[8:11], v[104:107], v[72:75], v[8:11]
    ds_read_b64_tr_b16 v[112:113], v179 offset:4096
    ds_read_b64_tr_b16 v[114:115], v179 offset:4608
    v_mfma_f32_16x16x32_bf16 v[12:15], v[104:107], v[76:79], v[12:15]
    ds_read_b64_tr_b16 v[116:117], v181 offset:4096
    ds_read_b64_tr_b16 v[118:119], v181 offset:4608
    v_mfma_f32_16x16x32_bf16 v[16:19], v[104:107], v[80:83], v[16:19]
    ds_read_b128 v[88:91], v178 offset:1024
    ds_read_b128 v[92:95], v178 offset:3072
    v_mfma_f32_16x16x32_bf16 v[20:23], v[104:107], v[84:87], v[20:23]
    ds_read_b128 v[96:99], v178 offset:5120
    ds_read_b128 v[100:103], v178 offset:7168
    v_mfma_f32_16x16x32_bf16 v[36:39], v[108:111], v[84:87], v[36:39]
    s_add_u32 s17, s17, 32768
    s_cmp_eq_u32 s17, 131072
    v_mfma_f32_16x16x32_bf16 v[32:35], v[108:111], v[80:83], v[32:35]
    s_cselect_b32 s17, 0, s17
    v_add_u32 v178, s17, v176
    v_mfma_f32_16x16x32_bf16 v[28:31], v[108:111], v[76:79], v[28:31]
    v_add_u32 v179, s17, v177
    v_mfma_f32_16x16x32_bf16 v[24:27], v[108:111], v[72:75], v[24:27]
    v_add_u32 v181, s17, v180
    s_waitcnt lgkmcnt(0)
    s_barrier
    s_cmp_lg_u32 s59, 0
    s_cbranch_scc1 m_kernel_done5
m_kernel_poll5:
    s_waitcnt vmcnt(0)
    v_readfirstlane_b32 s59, v240
    s_nop 0
    s_cmp_eq_u32 s59, 1
    s_cbranch_scc1 m_kernel_got5
    s_mov_b32 s59, 0
    buffer_load_dword v240, v183, s[36:39], s55 offen sc1
    s_branch m_kernel_done5
m_kernel_got5:
    buffer_load_dwordx4 v[224:227], v182, s[40:43], s57 offen offset:0 sc1
    buffer_load_dwordx4 v[228:231], v182, s[40:43], s57 offen offset:1024 sc1
    buffer_load_dwordx4 v[232:235], v182, s[40:43], s57 offen offset:2048 sc1
    buffer_load_dwordx4 v[236:239], v182, s[40:43], s57 offen offset:3072 sc1
m_kernel_done5:
    v_mfma_f32_16x16x32_bf16 v[8:11], v[112:115], v[88:91], v[8:11]
    ds_read_b64_tr_b16 v[104:105], v179 offset:0
    v_mfma_f32_16x16x32_bf16 v[12:15], v[112:115], v[92:95], v[12:15]
    ds_read_b64_tr_b16 v[106:107], v179 offset:512
    v_mfma_f32_16x16x32_bf16 v[16:19], v[112:115], v[96:99], v[16:19]
    ds_read_b64_tr_b16 v[108:109], v181 offset:0
    v_mfma_f32_16x16x32_bf16 v[20:23], v[112:115], v[100:103], v[20:23]
    ds_read_b64_tr_b16 v[110:111], v181 offset:512
    v_mfma_f32_16x16x32_bf16 v[36:39], v[116:119], v[100:103], v[36:39]
    ds_read_b128 v[72:75], v178 offset:0
    v_mfma_f32_16x16x32_bf16 v[32:35], v[116:119], v[96:99], v[32:35]
    ds_read_b128 v[76:79], v178 offset:2048
    v_mfma_f32_16x16x32_bf16 v[28:31], v[116:119], v[92:95], v[28:31]
    ds_read_b128 v[80:83], v178 offset:4096
    v_mfma_f32_16x16x32_bf16 v[24:27], v[116:119], v[88:91], v[24:27]
    ds_read_b128 v[84:87], v178 offset:6144
    s_waitcnt lgkmcnt(0)
    v_lshlrev_b32 v204, 16, v148
    v_and_b32 v205, 0xffff0000, v148
    v_lshlrev_b32 v206, 16, v149
    v_and_b32 v207, 0xffff0000, v149
    v_pk_add_f32 v[204:205], v[204:205], v[184:185]
    v_pk_add_f32 v[206:207], v[206:207], v[186:187]
    v_add_f32 v204, v204, v163
    v_add_f32 v205, v205, v163
    v_add_f32 v206, v206, v163
    v_add_f32 v207, v207, v163
    v_lshlrev_b32 v220, 16, v150
    v_and_b32 v221, 0xffff0000, v150
    v_lshlrev_b32 v222, 16, v151
    v_and_b32 v223, 0xffff0000, v151
    v_pk_add_f32 v[220:221], v[220:221], v[188:189]
    v_pk_add_f32 v[222:223], v[222:223], v[190:191]
    v_add_f32 v220, v220, v163
    v_add_f32 v221, v221, v163
    v_add_f32 v222, v222, v163
    v_add_f32 v223, v223, v163
    v_mfma_f32_16x16x32_bf16 v[8:11], v[104:107], v[72:75], v[8:11]
    ds_read_b64_tr_b16 v[112:113], v179 offset:4096
    ds_read_b64_tr_b16 v[114:115], v179 offset:4608
    v_mfma_f32_16x16x32_bf16 v[12:15], v[104:107], v[76:79], v[12:15]
    ds_read_b64_tr_b16 v[116:117], v181 offset:4096
    ds_read_b64_tr_b16 v[118:119], v181 offset:4608
    v_mfma_f32_16x16x32_bf16 v[16:19], v[104:107], v[80:83], v[16:19]
    ds_read_b128 v[88:91], v178 offset:1024
    ds_read_b128 v[92:95], v178 offset:3072
    v_mfma_f32_16x16x32_bf16 v[20:23], v[104:107], v[84:87], v[20:23]
    ds_read_b128 v[96:99], v178 offset:5120
    ds_read_b128 v[100:103], v178 offset:7168
    v_mfma_f32_16x16x32_bf16 v[36:39], v[108:111], v[84:87], v[36:39]
    s_add_u32 s17, s17, 32768
    s_cmp_eq_u32 s17, 131072
    v_mfma_f32_16x16x32_bf16 v[32:35], v[108:111], v[80:83], v[32:35]
    s_cselect_b32 s17, 0, s17
    v_add_u32 v178, s17, v176
    v_mfma_f32_16x16x32_bf16 v[28:31], v[108:111], v[76:79], v[28:31]
    v_add_u32 v179, s17, v177
    v_mfma_f32_16x16x32_bf16 v[24:27], v[108:111], v[72:75], v[24:27]
    v_add_u32 v181, s17, v180
    s_waitcnt lgkmcnt(0)
    s_barrier
    s_cmp_lg_u32 s59, 0
    s_cbranch_scc1 m_kernel_done6
m_kernel_poll6:
    s_waitcnt vmcnt(0)
    v_readfirstlane_b32 s59, v240
    s_nop 0
    s_cmp_eq_u32 s59, 1
    s_cbranch_scc1 m_kernel_got6
    s_mov_b32 s59, 0
    buffer_load_dword v240, v183, s[36:39], s55 offen sc1
    s_branch m_kernel_done6
m_kernel_got6:
    buffer_load_dwordx4 v[224:227], v182, s[40:43], s57 offen offset:0 sc1
    buffer_load_dwordx4 v[228:231], v182, s[40:43], s57 offen offset:1024 sc1
    buffer_load_dwordx4 v[232:235], v182, s[40:43], s57 offen offset:2048 sc1
    buffer_load_dwordx4 v[236:239], v182, s[40:43], s57 offen offset:3072 sc1
m_kernel_done6:
    v_mfma_f32_16x16x32_bf16 v[8:11], v[112:115], v[88:91], v[8:11]
    ds_read_b64_tr_b16 v[104:105], v179 offset:0
    v_mfma_f32_16x16x32_bf16 v[12:15], v[112:115], v[92:95], v[12:15]
    ds_read_b64_tr_b16 v[106:107], v179 offset:512
    v_mfma_f32_16x16x32_bf16 v[16:19], v[112:115], v[96:99], v[16:19]
    ds_read_b64_tr_b16 v[108:109], v181 offset:0
    v_mfma_f32_16x16x32_bf16 v[20:23], v[112:115], v[100:103], v[20:23]
    ds_read_b64_tr_b16 v[110:111], v181 offset:512
    v_mfma_f32_16x16x32_bf16 v[36:39], v[116:119], v[100:103], v[36:39]
    ds_read_b128 v[72:75], v178 offset:0
    v_mfma_f32_16x16x32_bf16 v[32:35], v[116:119], v[96:99], v[32:35]
    ds_read_b128 v[76:79], v178 offset:2048
    v_mfma_f32_16x16x32_bf16 v[28:31], v[116:119], v[92:95], v[28:31]
    ds_read_b128 v[80:83], v178 offset:4096
    v_mfma_f32_16x16x32_bf16 v[24:27], v[116:119], v[88:91], v[24:27]
    ds_read_b128 v[84:87], v178 offset:6144
    s_waitcnt lgkmcnt(0)
    v_mfma_f32_16x16x32_bf16 v[8:11], v[104:107], v[72:75], v[8:11]
    ds_read_b64_tr_b16 v[112:113], v179 offset:4096
    ds_read_b64_tr_b16 v[114:115], v179 offset:4608
    v_mfma_f32_16x16x32_bf16 v[12:15], v[104:107], v[76:79], v[12:15]
    ds_read_b64_tr_b16 v[116:117], v181 offset:4096
    ds_read_b64_tr_b16 v[118:119], v181 offset:4608
    v_mfma_f32_16x16x32_bf16 v[16:19], v[104:107], v[80:83], v[16:19]
    ds_read_b128 v[88:91], v178 offset:1024
    ds_read_b128 v[92:95], v178 offset:3072
    v_mfma_f32_16x16x32_bf16 v[20:23], v[104:107], v[84:87], v[20:23]
    ds_read_b128 v[96:99], v178 offset:5120
    ds_read_b128 v[100:103], v178 offset:7168
    v_mfma_f32_16x16x32_bf16 v[36:39], v[108:111], v[84:87], v[36:39]
    s_add_u32 s17, s17, 32768
    s_cmp_eq_u32 s17, 131072
    v_mfma_f32_16x16x32_bf16 v[32:35], v[108:111], v[80:83], v[32:35]
    s_cselect_b32 s17, 0, s17
    v_add_u32 v178, s17, v176
    v_mfma_f32_16x16x32_bf16 v[28:31], v[108:111], v[76:79], v[28:31]
    v_add_u32 v179, s17, v177
    v_mfma_f32_16x16x32_bf16 v[24:27], v[108:111], v[72:75], v[24:27]
    v_add_u32 v181, s17, v180
    s_waitcnt lgkmcnt(0)
    s_barrier
    s_cmp_lg_u32 s59, 0
    s_cbranch_scc1 m_kernel_done7
m_kernel_poll7:
    s_waitcnt vmcnt(0)
    v_readfirstlane_b32 s59, v240
    s_nop 0
    s_cmp_eq_u32 s59, 1
    s_cbranch_scc1 m_kernel_got7
    s_mov_b32 s59, 0
    buffer_load_dword v240, v183, s[36:39], s55 offen sc1
    s_branch m_kernel_done7
m_kernel_got7:
    buffer_load_dwordx4 v[224:227], v182, s[40:43], s57 offen offset:0 sc1
    buffer_load_dwordx4 v[228:231], v182, s[40:43], s57 offen offset:1024 sc1
    buffer_load_dwordx4 v[232:235], v182, s[40:43], s57 offen offset:2048 sc1
    buffer_load_dwordx4 v[236:239], v182, s[40:43], s57 offen offset:3072 sc1
m_kernel_done7:
    v_mfma_f32_16x16x32_bf16 v[8:11], v[112:115], v[88:91], v[8:11]
    ds_read_b64_tr_b16 v[104:105], v179 offset:0
    v_mfma_f32_16x16x32_bf16 v[12:15], v[112:115], v[92:95], v[12:15]
    ds_read_b64_tr_b16 v[106:107], v179 offset:512
    v_mfma_f32_16x16x32_bf16 v[16:19], v[112:115], v[96:99], v[16:19]
    ds_read_b64_tr_b16 v[108:109], v181 offset:0
    v_mfma_f32_16x16x32_bf16 v[20:23], v[112:115], v[100:103], v[20:23]
    ds_read_b64_tr_b16 v[110:111], v181 offset:512
    v_mfma_f32_16x16x32_bf16 v[36:39], v[116:119], v[100:103], v[36:39]
    ds_read_b128 v[72:75], v178 offset:0
    v_mfma_f32_16x16x32_bf16 v[32:35], v[116:119], v[96:99], v[32:35]
    ds_read_b128 v[76:79], v178 offset:2048
    v_mfma_f32_16x16x32_bf16 v[28:31], v[116:119], v[92:95], v[28:31]
    ds_read_b128 v[80:83], v178 offset:4096
    v_mfma_f32_16x16x32_bf16 v[24:27], v[116:119], v[88:91], v[24:27]
    ds_read_b128 v[84:87], v178 offset:6144
    s_waitcnt lgkmcnt(0)
    v_mfma_f32_16x16x32_bf16 v[8:11], v[104:107], v[72:75], v[8:11]
    ds_read_b64_tr_b16 v[112:113], v179 offset:4096
    v_mfma_f32_16x16x32_bf16 v[12:15], v[104:107], v[76:79], v[12:15]
    ds_read_b64_tr_b16 v[114:115], v179 offset:4608
    v_mfma_f32_16x16x32_bf16 v[16:19], v[104:107], v[80:83], v[16:19]
    ds_read_b64_tr_b16 v[116:117], v181 offset:4096
    v_mfma_f32_16x16x32_bf16 v[20:23], v[104:107], v[84:87], v[20:23]
    ds_read_b64_tr_b16 v[118:119], v181 offset:4608
    v_mfma_f32_16x16x32_bf16 v[36:39], v[108:111], v[84:87], v[36:39]
    ds_read_b128 v[88:91], v178 offset:1024
    v_mfma_f32_16x16x32_bf16 v[32:35], v[108:111], v[80:83], v[32:35]
    ds_read_b128 v[92:95], v178 offset:3072
    v_mfma_f32_16x16x32_bf16 v[28:31], v[108:111], v[76:79], v[28:31]
    ds_read_b128 v[96:99], v178 offset:5120
    v_mfma_f32_16x16x32_bf16 v[24:27], v[108:111], v[72:75], v[24:27]
    ds_read_b128 v[100:103], v178 offset:7168
    s_waitcnt lgkmcnt(0)
    s_cmp_lg_u32 s59, 0
    s_cbranch_scc1 m_kernel_doneL
m_kernel_pollL:
    s_waitcnt vmcnt(0)
    v_readfirstlane_b32 s59, v240
    s_nop 0
    s_cmp_eq_u32 s59, 1
    s_cbranch_scc1 m_kernel_gotL
    s_mov_b32 s59, 0
    s_sub_u32 s58, s58, 1
    s_cbranch_scc1 m_kernel_gotL
    s_sleep 1
    buffer_load_dword v240, v183, s[36:39], s55 offen sc1
    s_branch m_kernel_pollL
m_kernel_gotL:
    buffer_load_dwordx4 v[224:227], v182, s[40:43], s57 offen offset:0 sc1
    buffer_load_dwordx4 v[228:231], v182, s[40:43], s57 offen offset:1024 sc1
    buffer_load_dwordx4 v[232:235], v182, s[40:43], s57 offen offset:2048 sc1
    buffer_load_dwordx4 v[236:239], v182, s[40:43], s57 offen offset:3072 sc1
m_kernel_doneL:
    v_mfma_f32_16x16x32_bf16 v[8:11], v[112:115], v[88:91], v[8:11]
    v_mfma_f32_16x16x32_bf16 v[12:15], v[112:115], v[92:95], v[12:15]
    v_mfma_f32_16x16x32_bf16 v[16:19], v[112:115], v[96:99], v[16:19]
    v_mfma_f32_16x16x32_bf16 v[20:23], v[112:115], v[100:103], v[20:23]
    v_mfma_f32_16x16x32_bf16 v[36:39], v[116:119], v[100:103], v[36:39]
    v_mfma_f32_16x16x32_bf16 v[32:35], v[116:119], v[96:99], v[32:35]
    v_mfma_f32_16x16x32_bf16 v[28:31], v[116:119], v[92:95], v[28:31]
    v_mfma_f32_16x16x32_bf16 v[24:27], v[116:119], v[88:91], v[24:27]
    s_waitcnt lgkmcnt(0)
    s_waitcnt vmcnt(0)
    v_dot2_f32_bf16 v8, v224, s60, v8
    v_dot2_f32_bf16 v9, v224, s61, v9
    v_dot2_f32_bf16 v10, v225, s60, v10
    v_dot2_f32_bf16 v11, v225, s61, v11
    s_nop 1
    v_dot2_f32_bf16 v24, v232, s60, v24
    v_dot2_f32_bf16 v25, v232, s61, v25
    v_dot2_f32_bf16 v26, v233, s60, v26
    v_dot2_f32_bf16 v27, v233, s61, v27
    v_fma_f32 v8, v8, v152, v192
    v_fma_f32 v9, v9, v152, v193
    v_fma_f32 v10, v10, v152, v194
    v_fma_f32 v11, v11, v152, v195
    v_fma_f32 v24, v24, v152, v208
    v_fma_f32 v25, v25, v152, v209
    v_fma_f32 v26, v26, v152, v210
    v_fma_f32 v27, v27, v152, v211
    v_cvt_pk_bf16_f32 v40, v8, v9
    v_cvt_pk_bf16_f32 v41, v10, v11
    v_cvt_pk_bf16_f32 v42, v24, v25
    v_cvt_pk_bf16_f32 v43, v26, v27
    s_nop 0
    v_permlane16_swap_b32 v40, v42
    v_permlane16_swap_b32 v41, v43
    ds_write_b128 v4, v[40:43] offset:0
    ds_read_b128 v[76:79], v5 offset:0
    v_dot2_f32_bf16 v12, v226, s60, v12
    v_dot2_f32_bf16 v13, v226, s61, v13
    v_dot2_f32_bf16 v14, v227, s60, v14
    v_dot2_f32_bf16 v15, v227, s61, v15
    v_dot2_f32_bf16 v28, v234, s60, v28
    v_dot2_f32_bf16 v29, v234, s61, v29
    v_dot2_f32_bf16 v30, v235, s60, v30
    v_dot2_f32_bf16 v31, v235, s61, v31
    v_fma_f32 v12, v12, v153, v196
    v_fma_f32 v13, v13, v153, v197
    v_fma_f32 v14, v14, v153, v198
    v_fma_f32 v15, v15, v153, v199
    v_fma_f32 v28, v28, v153, v212
    v_fma_f32 v29, v29, v153, v213
    v_fma_f32 v30, v30, v153, v214
    v_fma_f32 v31, v31, v153, v215
    v_cvt_pk_bf16_f32 v44, v12, v13
    v_cvt_pk_bf16_f32 v45, v14, v15
    v_cvt_pk_bf16_f32 v46, v28, v29
    v_cvt_pk_bf16_f32 v47, v30, v31
    s_nop 0
    v_permlane16_swap_b32 v44, v46
    v_permlane16_swap_b32 v45, v47
    ds_write_b128 v4, v[44:47] offset:1024
    ds_read_b128 v[80:83], v5 offset:1024
    s_waitcnt lgkmcnt(2)
    buffer_store_dwordx4 v[76:79], v6, s[32:35], s19 offen sc1
    s_add_u32 s19, s19, 524288
    v_dot2_f32_bf16 v16, v228, s60, v16
    v_dot2_f32_bf16 v17, v228, s61, v17
    v_dot2_f32_bf16 v18, v229, s60, v18
    v_dot2_f32_bf16 v19, v229, s61, v19
    v_dot2_f32_bf16 v32, v236, s60, v32
    v_dot2_f32_bf16 v33, v236, s61, v33
    v_dot2_f32_bf16 v34, v237, s60, v34
    v_dot2_f32_bf16 v35, v237, s61, v35
    v_fma_f32 v16, v16, v154, v200
    v_fma_f32 v17, v17, v154, v201
    v_fma_f32 v18, v18, v154, v202
    v_fma_f32 v19, v19, v154, v203
    v_fma_f32 v32, v32, v154, v216
    v_fma_f32 v33, v33, v154, v217
    v_fma_f32 v34, v34, v154, v218
    v_fma_f32 v35, v35, v154, v219
    v_cvt_pk_bf16_f32 v48, v16, v17
    v_cvt_pk_bf16_f32 v49, v18, v19
    v_cvt_pk_bf16_f32 v50, v32, v33
    v_cvt_pk_bf16_f32 v51, v34, v35
    s_nop 0
    v_permlane16_swap_b32 v48, v50
    v_permlane16_swap_b32 v49, v51
    ds_write_b128 v4, v[48:51] offset:2048
    ds_read_b128 v[84:87], v5 offset:2048
    s_waitcnt lgkmcnt(2)
    buffer_store_dwordx4 v[80:83], v6, s[32:35], s19 offen sc1
    s_add_u32 s19, s19, 524288
    v_dot2_f32_bf16 v20, v230, s60, v20
    v_dot2_f32_bf16 v21, v230, s61, v21
    v_dot2_f32_bf16 v22, v231, s60, v22
    v_dot2_f32_bf16 v23, v231, s61, v23
    v_dot2_f32_bf16 v36, v238, s60, v36
    v_dot2_f32_bf16 v37, v238, s61, v37
    v_dot2_f32_bf16 v38, v239, s60, v38
    v_dot2_f32_bf16 v39, v239, s61, v39
    v_fma_f32 v20, v20, v155, v204
    v_fma_f32 v21, v21, v155, v205
    v_fma_f32 v22, v22, v155, v206
    v_fma_f32 v23, v23, v155, v207
    v_fma_f32 v36, v36, v155, v220
    v_fma_f32 v37, v37, v155, v221
    v_fma_f32 v38, v38, v155, v222
    v_fma_f32 v39, v39, v155, v223
    v_cvt_pk_bf16_f32 v52, v20, v21
    v_cvt_pk_bf16_f32 v53, v22, v23
    v_cvt_pk_bf16_f32 v54, v36, v37
    v_cvt_pk_bf16_f32 v55, v38, v39
    s_nop 0
    v_permlane16_swap_b32 v52, v54
    v_permlane16_swap_b32 v53, v55
    ds_write_b128 v4, v[52:55] offset:3072
    ds_read_b128 v[88:91], v5 offset:3072
    s_waitcnt lgkmcnt(2)
    buffer_store_dwordx4 v[84:87], v6, s[32:35], s19 offen sc1
    s_add_u32 s19, s19, 524288
    s_waitcnt lgkmcnt(0)
    buffer_store_dwordx4 v[88:91], v6, s[32:35], s19 offen sc1
    s_endpgm
m_kernel_loader:
    s_load_dwordx4 s[64:67], s[0:1], 48
    s_load_dwordx4 s[48:51], s[0:1], 64
    s_sub_u32 s12, s12, 4
    s_and_b32 s8, s2, 7
    s_lshr_b32 s9, s2, 3
    s_and_b32 s10, s8, 1
    s_lshl_b32 s10, s10, 3
    s_and_b32 s11, s9, 7
    s_add_u32 s10, s10, s11
    s_lshr_b32 s11, s8, 1
    s_lshl_b32 s11, s11, 2
    s_lshr_b32 s9, s9, 3
    s_add_u32 s11, s11, s9
    s_lshl_b32 s15, s12, 17
    v_lshlrev_b32 v8, 4, v1
    v_cmp_lt_u32 vcc, 383, v8
    v_add_u32 v9, 128, v8
    s_nop 0
    v_cndmask_b32 v8, v8, v9, vcc
    v_add_u32 v8, s15, v8
    v_add_u32 v9, 0x10000, v8
    s_lshr_b32 s15, s12, 1
    s_lshl_b32 s15, s15, 6
    s_and_b32 s16, s12, 1
    s_lshl_b32 s16, s16, 4
    s_add_u32 s15, s15, s16
    s_and_b32 s16, s11, 1
    v_and_b32 v7, 1, v1
    v_lshlrev_b32 v7, 4, v7
    v_lshrrev_b32 v4, 3, v1
    v_lshrrev_b32 v5, 4, v1
    v_lshrrev_b32 v6, 1, v1
    v_xor_b32 v5, v5, v6
    v_and_b32 v5, 3, v5
    v_add_u32 v4, s15, v4
    v_mul_u32_u24 v4, 7168, v4
    v_lshl_add_u32 v4, v5, 5, v4
    s_lshl_b32 s92, s16, 6
    v_add3_u32 v6, v4, v7, s92
    v_lshrrev_b32 v4, 2, v1
    v_lshrrev_b32 v5, 3, v1
    v_xor_b32 v5, v5, v1
    v_and_b32 v5, 2, v5
    v_add_u32 v4, s15, v4
    v_mul_u32_u24 v4, 7168, v4
    v_lshl_add_u32 v4, v5, 4, v4
    s_mul_i32 s93, s16, 384
    s_sub_u32 s93, 384, s93
    v_add3_u32 v4, v4, v7, s93
    v_add_u32 v10, 0, v6
    v_add_u32 v11, 128, v6
    v_add_u32 v12, 256, v6
    v_add_u32 v13, 57344, v6
    v_add_u32 v14, 57472, v6
    v_add_u32 v15, 57600, v6
    v_mov_b32 v16, v4
    s_lshl_b32 s43, s12, 12
    s_mul_i32 s44, s12, 7168
    s_add_u32 s44, s44, 49152
    s_mov_b32 s41, 0
    s_mov_b32 s42, 0
    s_lshl_b32 s15, s12, 8
    v_and_b32 v3, 15, v1
    v_lshlrev_b32 v3, 4, v3
    v_lshrrev_b32 v4, 4, v1
    v_lshl_add_u32 v3, v4, 10, v3
    v_add_u32 v3, s15, v3
    v_and_b32 v17, 15, v1
    v_lshlrev_b32 v17, 7, v17
    v_mov_b32 v20, 1
    v_mov_b32 v21, 0
    s_and_b32 s13, s2, 7
    s_sub_u32 s15, 16, s13
    s_cmp_eq_u32 s13, 0
    s_cselect_b32 s15, 8, s15
    s_bitcmp1_b32 s2, 3
    s_cselect_b32 s13, s15, s13
    s_lshl_b32 s13, s13, 4
    s_lshr_b32 s15, s2, 4
    s_add_u32 s13, s13, s15
    s_lshl_b32 s13, s13, 7
    s_lshl_b32 s14, s10, 4
    s_add_u32 s14, s14, s11
    s_lshl_b32 s14, s14, 7
    s_add_u32 s14, s14, 32768
    s_lshl_b32 s15, s10, 19
    s_add_u32 s15, s15, 75497472
    s_mul_i32 s16, s11, 448
    s_sub_u32 s19, 7340032, s16
    s_waitcnt lgkmcnt(0)
    s_lshl_b32 s17, s12, 7
    s_add_u32 s18, s17, s16
    s_min_u32 s18, s18, 7040
    s_load_dwordx2 s[62:63], s[66:67], s18 offset:60
    s_and_b32 s18, s11, 3
    s_lshl_b32 s18, s18, 9
    s_add_u32 s18, s18, s17
    s_load_dwordx2 s[62:63], s[50:51], s18 offset:60
    s_add_u32 s20, s4, s15
    s_addc_u32 s21, s5, 0
    s_mov_b32 s22, 524288
    s_mov_b32 s23, 0x20000
    s_add_u32 s24, s64, s16
    s_addc_u32 s25, s65, 0
    s_mov_b32 s26, s19
    s_mov_b32 s27, 0x20000
    s_lshl_b32 s15, s10, 14
    s_add_u32 s15, s15, 28311552
    s_add_u32 s32, s4, s15
    s_addc_u32 s33, s5, 0
    s_mov_b32 s34, 16384
    s_mov_b32 s35, 0x20000
    s_lshl_b32 s15, s10, 9
    s_add_u32 s15, s15, 29097984
    s_add_u32 s36, s4, s15
    s_addc_u32 s37, s5, 0
    s_mov_b32 s38, 512
    s_mov_b32 s39, 0x20000
    s_add_u32 s52, s4, 39845888
    s_addc_u32 s53, s5, 0
    s_mov_b32 s54, 262144
    s_mov_b32 s55, 0x20000
    s_mov_b32 s56, s48
    s_mov_b32 s57, s49
    s_mov_b32 s58, 7340032
    s_mov_b32 s59, 0x20000
    s_lshl_b32 s60, s2, 2
    s_add_u32 s60, s60, s12
    s_mul_i32 s60, s60, 512
    s_mov_b32 s50, 4194304
    v_add_u32 v26, 3072, v8
    v_add_u32 v27, 3072, v9
    s_barrier
    s_add_u32 s45, 0, s44
    s_add_u32 m0, s45, 0
    s_nop 0
    buffer_load_dwordx4 v10, s[24:27], s42 offen lds
    s_add_u32 m0, s45, 1024
    s_nop 0
    buffer_load_dwordx4 v11, s[24:27], s42 offen lds
    s_add_u32 m0, s45, 2048
    s_nop 0
    buffer_load_dwordx4 v12, s[24:27], s42 offen lds
    s_add_u32 m0, s45, 3072
    s_nop 0
    buffer_load_dwordx4 v13, s[24:27], s42 offen lds
    s_add_u32 m0, s45, 4096
    s_nop 0
    buffer_load_dwordx4 v14, s[24:27], s42 offen lds
    s_add_u32 m0, s45, 5120
    s_nop 0
    buffer_load_dwordx4 v15, s[24:27], s42 offen lds
    s_add_u32 m0, s45, 6144
    s_nop 0
    buffer_load_dwordx4 v16, s[24:27], s42 offen lds
    s_add_u32 s42, s42, 917504
    s_buffer_load_dwordx2 s[62:63], s[56:59], s60 offset:60
    s_buffer_load_dwordx2 s[62:63], s[56:59], s60 offset:188
    s_buffer_load_dwordx2 s[62:63], s[56:59], s60 offset:316
    s_buffer_load_dwordx2 s[62:63], s[56:59], s60 offset:444
    s_add_u32 s60, s60, s50
    s_sub_u32 s50, 524288, s50
    s_buffer_load_dwordx2 s[62:63], s[56:59], s60 offset:60
    s_buffer_load_dwordx2 s[62:63], s[56:59], s60 offset:188
    s_buffer_load_dwordx2 s[62:63], s[56:59], s60 offset:316
    s_buffer_load_dwordx2 s[62:63], s[56:59], s60 offset:444
    s_add_u32 s60, s60, s50
    s_sub_u32 s50, 524288, s50
    s_lshl_b32 s15, s10, 11
    s_barrier
    s_cmp_lg_u32 s12, 0
    s_cbranch_scc1 m_kernel_f1
    buffer_store_dword v20, v21, s[52:55], s13 offen sc1
m_kernel_f1:
    s_add_u32 s45, 28672, s44
    s_add_u32 m0, s45, 0
    s_nop 0
    buffer_load_dwordx4 v10, s[24:27], s42 offen lds
    s_add_u32 m0, s45, 1024
    s_nop 0
    buffer_load_dwordx4 v11, s[24:27], s42 offen lds
    s_add_u32 m0, s45, 2048
    s_nop 0
    buffer_load_dwordx4 v12, s[24:27], s42 offen lds
    s_add_u32 m0, s45, 3072
    s_nop 0
    buffer_load_dwordx4 v13, s[24:27], s42 offen lds
    s_add_u32 m0, s45, 4096
    s_nop 0
    buffer_load_dwordx4 v14, s[24:27], s42 offen lds
    s_add_u32 m0, s45, 5120
    s_nop 0
    buffer_load_dwordx4 v15, s[24:27], s42 offen lds
    s_add_u32 m0, s45, 6144
    s_nop 0
    buffer_load_dwordx4 v16, s[24:27], s42 offen lds
    s_add_u32 s42, s42, 917504
    s_add_u32 s45, 57344, s44
    s_add_u32 m0, s45, 0
    s_nop 0
    buffer_load_dwordx4 v10, s[24:27], s42 offen lds
    s_add_u32 m0, s45, 1024
    s_nop 0
    buffer_load_dwordx4 v11, s[24:27], s42 offen lds
    s_add_u32 m0, s45, 2048
    s_nop 0
    buffer_load_dwordx4 v12, s[24:27], s42 offen lds
    s_add_u32 m0, s45, 3072
    s_nop 0
    buffer_load_dwordx4 v13, s[24:27], s42 offen lds
    s_add_u32 m0, s45, 4096
    s_nop 0
    buffer_load_dwordx4 v14, s[24:27], s42 offen lds
    s_add_u32 m0, s45, 5120
    s_nop 0
    buffer_load_dwordx4 v15, s[24:27], s42 offen lds
    s_add_u32 m0, s45, 6144
    s_nop 0
    buffer_load_dwordx4 v16, s[24:27], s42 offen lds
    s_add_u32 s42, s42, 917504
    s_cmp_lg_u32 s12, 0
    s_cbranch_scc1 m_kernel_fl1_go
    s_mov_b32 s47, 400000
m_kernel_fl1_spin:
    buffer_load_dword v36, v17, s[52:55], s15 offen sc1
    s_waitcnt vmcnt(0)
    v_cmp_ne_u32 vcc, 1, v36
    s_cbranch_vccz m_kernel_fl1_go
    s_sleep 1
    s_sub_u32 s47, s47, 1
    s_cbranch_scc0 m_kernel_fl1_spin
m_kernel_fl1_go:
    s_barrier
    s_add_u32 m0, 0, s43
    s_nop 0
    buffer_load_dwordx4 v8, s[20:23], s41 offen sc1 lds
    buffer_load_dwordx4 v26, s[20:23], s41 offen offset:1024 sc1 lds
    s_add_u32 m0, m0, 2048
    s_nop 0
    buffer_load_dwordx4 v9, s[20:23], s41 offen sc1 lds
    buffer_load_dwordx4 v27, s[20:23], s41 offen offset:1024 sc1 lds
    s_add_u32 s41, s41, 8192
    s_add_u32 m0, 16384, s43
    s_nop 0
    buffer_load_dwordx4 v8, s[20:23], s41 offen sc1 lds
    buffer_load_dwordx4 v26, s[20:23], s41 offen offset:1024 sc1 lds
    s_add_u32 m0, m0, 2048
    s_nop 0
    buffer_load_dwordx4 v9, s[20:23], s41 offen sc1 lds
    buffer_load_dwordx4 v27, s[20:23], s41 offen offset:1024 sc1 lds
    s_add_u32 s41, s41, 8192
    s_add_u32 m0, 32768, s43
    s_nop 0
    buffer_load_dwordx4 v8, s[20:23], s41 offen sc1 lds
    buffer_load_dwordx4 v26, s[20:23], s41 offen offset:1024 sc1 lds
    s_add_u32 m0, m0, 2048
    s_nop 0
    buffer_load_dwordx4 v9, s[20:23], s41 offen sc1 lds
    buffer_load_dwordx4 v27, s[20:23], s41 offen offset:1024 sc1 lds
    s_add_u32 s41, s41, 8192
    s_mov_b32 s40, 0
    s_mov_b32 s46, 0
    s_waitcnt vmcnt(8)
    s_barrier
    s_cmp_lg_u32 s12, 0
    s_cbranch_scc1 m_kernel_no5
    s_add_u32 s13, s13, 229376
    buffer_store_dword v20, v21, s[52:55], s13 offen sc1
m_kernel_no5:
    s_waitcnt vmcnt(4)
    s_barrier
    s_mov_b32 s18, 3
m_kernel_l1a:
    s_add_u32 m0, s40, s43
    s_nop 0
    buffer_load_dwordx4 v8, s[20:23], s41 offen sc1 lds
    buffer_load_dwordx4 v26, s[20:23], s41 offen offset:1024 sc1 lds
    s_add_u32 m0, m0, 2048
    s_nop 0
    buffer_load_dwordx4 v9, s[20:23], s41 offen sc1 lds
    buffer_load_dwordx4 v27, s[20:23], s41 offen offset:1024 sc1 lds
    s_add_u32 s41, s41, 8192
    s_add_u32 s45, s46, s44
    s_add_u32 m0, s45, 0
    s_nop 0
    buffer_load_dwordx4 v10, s[24:27], s42 offen lds
    s_add_u32 m0, s45, 1024
    s_nop 0
    buffer_load_dwordx4 v11, s[24:27], s42 offen lds
    s_add_u32 m0, s45, 2048
    s_nop 0
    buffer_load_dwordx4 v12, s[24:27], s42 offen lds
    s_add_u32 m0, s45, 3072
    s_nop 0
    buffer_load_dwordx4 v13, s[24:27], s42 offen lds
    s_add_u32 m0, s45, 4096
    s_nop 0
    buffer_load_dwordx4 v14, s[24:27], s42 offen lds
    s_add_u32 m0, s45, 5120
    s_nop 0
    buffer_load_dwordx4 v15, s[24:27], s42 offen lds
    s_add_u32 m0, s45, 6144
    s_nop 0
    buffer_load_dwordx4 v16, s[24:27], s42 offen lds
    s_add_u32 s42, s42, 917504
    s_add_u32 s40, s40, 16384
    s_add_u32 s46, s46, 28672
    s_cmp_eq_u32 s40, 49152
    s_cselect_b32 s40, 0, s40
    s_cselect_b32 s46, 0, s46
    s_buffer_load_dwordx2 s[62:63], s[56:59], s60 offset:60
    s_buffer_load_dwordx2 s[62:63], s[56:59], s60 offset:188
    s_buffer_load_dwordx2 s[62:63], s[56:59], s60 offset:316
    s_buffer_load_dwordx2 s[62:63], s[56:59], s60 offset:444
    s_add_u32 s60, s60, s50
    s_sub_u32 s50, 524288, s50
    s_add_u32 s18, s18, 1
    s_cmp_le_u32 s18, 4
    s_waitcnt vmcnt(11)
    s_barrier
    s_cbranch_scc1 m_kernel_l1a
    s_add_u32 s15, s15, 229376
    buffer_load_dword v36, v17, s[52:55], s15 offen sc1
    s_add_u32 m0, s40, s43
    s_nop 0
    buffer_load_dwordx4 v8, s[20:23], s41 offen sc1 lds
    buffer_load_dwordx4 v26, s[20:23], s41 offen offset:1024 sc1 lds
    s_add_u32 m0, m0, 2048
    s_nop 0
    buffer_load_dwordx4 v9, s[20:23], s41 offen sc1 lds
    buffer_load_dwordx4 v27, s[20:23], s41 offen offset:1024 sc1 lds
    s_add_u32 s41, s41, 8192
    s_add_u32 s45, s46, s44
    s_add_u32 m0, s45, 0
    s_nop 0
    buffer_load_dwordx4 v10, s[24:27], s42 offen lds
    s_add_u32 m0, s45, 1024
    s_nop 0
    buffer_load_dwordx4 v11, s[24:27], s42 offen lds
    s_add_u32 m0, s45, 2048
    s_nop 0
    buffer_load_dwordx4 v12, s[24:27], s42 offen lds
    s_add_u32 m0, s45, 3072
    s_nop 0
    buffer_load_dwordx4 v13, s[24:27], s42 offen lds
    s_add_u32 m0, s45, 4096
    s_nop 0
    buffer_load_dwordx4 v14, s[24:27], s42 offen lds
    s_add_u32 m0, s45, 5120
    s_nop 0
    buffer_load_dwordx4 v15, s[24:27], s42 offen lds
    s_add_u32 m0, s45, 6144
    s_nop 0
    buffer_load_dwordx4 v16, s[24:27], s42 offen lds
    s_add_u32 s42, s42, 917504
    s_add_u32 s40, s40, 16384
    s_add_u32 s46, s46, 28672
    s_cmp_eq_u32 s40, 49152
    s_cselect_b32 s40, 0, s40
    s_cselect_b32 s46, 0, s46
    s_buffer_load_dwordx2 s[62:63], s[56:59], s60 offset:60
    s_buffer_load_dwordx2 s[62:63], s[56:59], s60 offset:188
    s_buffer_load_dwordx2 s[62:63], s[56:59], s60 offset:316
    s_buffer_load_dwordx2 s[62:63], s[56:59], s60 offset:444
    s_add_u32 s60, s60, s50
    s_sub_u32 s50, 524288, s50
    s_waitcnt vmcnt(11)
    s_barrier
    v_cmp_ne_u32 vcc, 1, v36
    s_cbranch_vccz m_kernel_fl5_go
    s_mov_b32 s47, 400000
m_kernel_fl5_spin:
    buffer_load_dword v36, v17, s[52:55], s15 offen sc1
    s_waitcnt vmcnt(0)
    v_cmp_ne_u32 vcc, 1, v36
    s_cbranch_vccz m_kernel_fl5_go
    s_sleep 1
    s_sub_u32 s47, s47, 1
    s_cbranch_scc0 m_kernel_fl5_spin
m_kernel_fl5_go:
    s_mov_b32 s47, 0
    buffer_load_dwordx4 v[40:43], v3, s[32:35], s47 offen sc1
    s_mov_b32 s47, 4096
    buffer_load_dwordx4 v[44:47], v3, s[32:35], s47 offen sc1
    s_mov_b32 s47, 8192
    buffer_load_dwordx4 v[48:51], v3, s[32:35], s47 offen sc1
    s_mov_b32 s47, 12288
    buffer_load_dwordx4 v[52:55], v3, s[32:35], s47 offen sc1
    s_mov_b32 s18, 6
m_kernel_l1b:
    s_add_u32 m0, s40, s43
    s_nop 0
    buffer_load_dwordx4 v8, s[20:23], s41 offen sc1 lds
    buffer_load_dwordx4 v26, s[20:23], s41 offen offset:1024 sc1 lds
    s_add_u32 m0, m0, 2048
    s_nop 0
    buffer_load_dwordx4 v9, s[20:23], s41 offen sc1 lds
    buffer_load_dwordx4 v27, s[20:23], s41 offen offset:1024 sc1 lds
    s_add_u32 s41, s41, 8192
    s_add_u32 s45, s46, s44
    s_add_u32 m0, s45, 0
    s_nop 0
    buffer_load_dwordx4 v10, s[24:27], s42 offen lds
    s_add_u32 m0, s45, 1024
    s_nop 0
    buffer_load_dwordx4 v11, s[24:27], s42 offen lds
    s_add_u32 m0, s45, 2048
    s_nop 0
    buffer_load_dwordx4 v12, s[24:27], s42 offen lds
    s_add_u32 m0, s45, 3072
    s_nop 0
    buffer_load_dwordx4 v13, s[24:27], s42 offen lds
    s_add_u32 m0, s45, 4096
    s_nop 0
    buffer_load_dwordx4 v14, s[24:27], s42 offen lds
    s_add_u32 m0, s45, 5120
    s_nop 0
    buffer_load_dwordx4 v15, s[24:27], s42 offen lds
    s_add_u32 m0, s45, 6144
    s_nop 0
    buffer_load_dwordx4 v16, s[24:27], s42 offen lds
    s_add_u32 s42, s42, 917504
    s_add_u32 s40, s40, 16384
    s_add_u32 s46, s46, 28672
    s_cmp_eq_u32 s40, 49152
    s_cselect_b32 s40, 0, s40
    s_cselect_b32 s46, 0, s46
    s_buffer_load_dwordx2 s[62:63], s[56:59], s60 offset:60
    s_buffer_load_dwordx2 s[62:63], s[56:59], s60 offset:188
    s_buffer_load_dwordx2 s[62:63], s[56:59], s60 offset:316
    s_buffer_load_dwordx2 s[62:63], s[56:59], s60 offset:444
    s_add_u32 s60, s60, s50
    s_sub_u32 s50, 524288, s50
    s_add_u32 s18, s18, 1
    s_cmp_le_u32 s18, 7
    s_waitcnt vmcnt(11)
    s_barrier
    s_cbranch_scc1 m_kernel_l1b
    s_mov_b32 s41, 2048
    s_mov_b32 s42, 229376
    s_add_u32 m0, s40, s43
    s_nop 0
    buffer_load_dwordx4 v8, s[20:23], s41 offen sc1 lds
    buffer_load_dwordx4 v26, s[20:23], s41 offen offset:1024 sc1 lds
    s_add_u32 m0, m0, 2048
    s_nop 0
    buffer_load_dwordx4 v9, s[20:23], s41 offen sc1 lds
    buffer_load_dwordx4 v27, s[20:23], s41 offen offset:1024 sc1 lds
    s_add_u32 s41, s41, 8192
    s_add_u32 s45, s46, s44
    s_add_u32 m0, s45, 0
    s_nop 0
    buffer_load_dwordx4 v10, s[24:27], s42 offen lds
    s_add_u32 m0, s45, 1024
    s_nop 0
    buffer_load_dwordx4 v11, s[24:27], s42 offen lds
    s_add_u32 m0, s45, 2048
    s_nop 0
    buffer_load_dwordx4 v12, s[24:27], s42 offen lds
    s_add_u32 m0, s45, 3072
    s_nop 0
    buffer_load_dwordx4 v13, s[24:27], s42 offen lds
    s_add_u32 m0, s45, 4096
    s_nop 0
    buffer_load_dwordx4 v14, s[24:27], s42 offen lds
    s_add_u32 m0, s45, 5120
    s_nop 0
    buffer_load_dwordx4 v15, s[24:27], s42 offen lds
    s_add_u32 m0, s45, 6144
    s_nop 0
    buffer_load_dwordx4 v16, s[24:27], s42 offen lds
    s_add_u32 s42, s42, 917504
    s_add_u32 s40, s40, 16384
    s_add_u32 s46, s46, 28672
    s_cmp_eq_u32 s40, 49152
    s_cselect_b32 s40, 0, s40
    s_cselect_b32 s46, 0, s46
    s_buffer_load_dwordx2 s[62:63], s[56:59], s60 offset:60
    s_buffer_load_dwordx2 s[62:63], s[56:59], s60 offset:188
    s_buffer_load_dwordx2 s[62:63], s[56:59], s60 offset:316
    s_buffer_load_dwordx2 s[62:63], s[56:59], s60 offset:444
    s_add_u32 s60, s60, s50
    s_sub_u32 s50, 524288, s50
    v_add_f32 v40, v40, v44
    v_add_f32 v48, v48, v52
    v_add_f32 v41, v41, v45
    v_add_f32 v49, v49, v53
    v_add_f32 v42, v42, v46
    v_add_f32 v50, v50, v54
    v_add_f32 v43, v43, v47
    v_add_f32 v51, v51, v55
    v_add_f32 v40, v40, v48
    v_add_f32 v41, v41, v49
    v_add_f32 v42, v42, v50
    v_add_f32 v43, v43, v51
    s_nop 0
    v_permlane32_swap_b32 v40, v42
    v_permlane32_swap_b32 v41, v43
    v_add_f32 v40, v40, v42
    v_add_f32 v41, v41, v43
    v_mov_b32 v42, v40
    v_mov_b32 v43, v41
    s_nop 0
    v_permlane16_swap_b32 v40, v42
    v_permlane16_swap_b32 v41, v43
    v_add_f32 v40, v40, v42
    v_add_f32 v41, v41, v43
    s_mov_b32 s47, 0x3a800000
    v_mul_f32 v22, s47, v40
    v_mul_f32 v24, s47, v41
    v_fma_f32 v24, -v22, v22, v24
    v_max_f32 v24, 0, v24
    v_cvt_pk_bf16_f32 v24, v24, v22
    v_and_b32 v22, 0xffff0000, v24
    v_lshlrev_b32 v24, 16, v24
    v_add_f32 v24, 0x3727c5ac, v24
    v_cvt_pk_bf16_f32 v24, v24, v24
    v_lshlrev_b32 v24, 16, v24
    v_sqrt_f32 v24, v24
    s_nop 0
    v_cvt_pk_bf16_f32 v24, v24, v24
    v_lshlrev_b32 v23, 16, v24
    v_lshrrev_b32 v28, 16, v23
    v_and_b32 v4, 15, v1
    v_lshrrev_b32 v5, 5, v1
    v_lshl_add_u32 v2, v4, 1, v5
    s_lshl_b32 s15, s12, 7
    s_add_u32 s15, s15, 136192
    v_lshl_add_u32 v5, v2, 2, s15
    ds_write_b32 v5, v28
    v_mul_f32 v23, v23, v23
    v_rcp_f32 v23, v23
    s_lshl_b32 s15, s12, 7
    v_lshlrev_b32 v5, 2, v2
    buffer_store_dword v23, v5, s[36:39], s15 offen sc1
    s_waitcnt vmcnt(12)
    s_barrier
    s_mov_b32 s18, 9
m_kernel_l1c:
    s_add_u32 m0, s40, s43
    s_nop 0
    buffer_load_dwordx4 v8, s[20:23], s41 offen sc1 lds
    buffer_load_dwordx4 v26, s[20:23], s41 offen offset:1024 sc1 lds
    s_add_u32 m0, m0, 2048
    s_nop 0
    buffer_load_dwordx4 v9, s[20:23], s41 offen sc1 lds
    buffer_load_dwordx4 v27, s[20:23], s41 offen offset:1024 sc1 lds
    s_add_u32 s41, s41, 8192
    s_add_u32 s45, s46, s44
    s_add_u32 m0, s45, 0
    s_nop 0
    buffer_load_dwordx4 v10, s[24:27], s42 offen lds
    s_add_u32 m0, s45, 1024
    s_nop 0
    buffer_load_dwordx4 v11, s[24:27], s42 offen lds
    s_add_u32 m0, s45, 2048
    s_nop 0
    buffer_load_dwordx4 v12, s[24:27], s42 offen lds
    s_add_u32 m0, s45, 3072
    s_nop 0
    buffer_load_dwordx4 v13, s[24:27], s42 offen lds
    s_add_u32 m0, s45, 4096
    s_nop 0
    buffer_load_dwordx4 v14, s[24:27], s42 offen lds
    s_add_u32 m0, s45, 5120
    s_nop 0
    buffer_load_dwordx4 v15, s[24:27], s42 offen lds
    s_add_u32 m0, s45, 6144
    s_nop 0
    buffer_load_dwordx4 v16, s[24:27], s42 offen lds
    s_add_u32 s42, s42, 917504
    s_add_u32 s40, s40, 16384
    s_add_u32 s46, s46, 28672
    s_cmp_eq_u32 s40, 49152
    s_cselect_b32 s40, 0, s40
    s_cselect_b32 s46, 0, s46
    s_cmp_eq_u32 s18, 15
    s_cbranch_scc1 m_kernel_nosp
    s_cmp_eq_u32 s18, 13
    s_cselect_b32 s50, 0x80000, s50
    s_buffer_load_dwordx2 s[62:63], s[56:59], s60 offset:60
    s_buffer_load_dwordx2 s[62:63], s[56:59], s60 offset:188
    s_buffer_load_dwordx2 s[62:63], s[56:59], s60 offset:316
    s_buffer_load_dwordx2 s[62:63], s[56:59], s60 offset:444
    s_add_u32 s60, s60, s50
    s_sub_u32 s50, 524288, s50
m_kernel_nosp:
    s_add_u32 s18, s18, 1
    s_cmp_le_u32 s18, 15
    s_waitcnt vmcnt(11)
    s_barrier
    s_cbranch_scc1 m_kernel_l1c
    s_waitcnt vmcnt(0) lgkmcnt(0)
    s_barrier
    s_mov_b32 s9, s11
    s_lshr_b32 s8, s9, 3
    s_and_b32 s11, s9, 7
    s_lshl_b32 s11, s11, 1
    s_add_u32 s11, s11, s8
    s_mul_i32 s15, s12, 344064
    v_lshlrev_b32 v8, 4, v1
    v_cmp_lt_u32 vcc, 255, v8
    v_add_u32 v26, 1152, v8
    v_add_u32 v4, 128, v26
    v_cndmask_b32 v26, v26, v4, vcc
    v_cmp_lt_u32 vcc, 383, v8
    v_add_u32 v4, 128, v8
    s_nop 0
    v_cndmask_b32 v8, v8, v4, vcc
    v_subrev_u32 v26, 1024, v26
    v_add_u32 v8, s15, v8
    v_add_u32 v26, s15, v26
    v_add_u32 v9, 172032, v8
    v_add_u32 v27, 172032, v26
    v_lshrrev_b32 v4, 3, v1
    s_lshl_b32 s15, s12, 4
    v_add_u32 v4, s15, v4
    v_lshlrev_b32 v4, 11, v4
    v_and_b32 v5, 1, v1
    v_lshl_add_u32 v4, v5, 4, v4
    v_lshrrev_b32 v5, 4, v1
    v_and_b32 v5, 1, v5
    v_lshrrev_b32 v6, 1, v1
    v_and_b32 v6, 3, v6
    v_xor_b32 v5, v5, v6
    v_lshl_add_u32 v4, v5, 5, v4
    v_xor_b32 v5, 64, v4
    v_add_u32 v5, 15360, v5
    v_lshrrev_b32 v6, 3, v1
    v_cmp_eq_u32 vcc, 3, v6
    s_nop 1
    v_cndmask_b32 v6, v6, 7, vcc
    s_mov_b32 s16, s11
    s_and_b32 s19, s16, 8
    v_add_u32 v7, s19, v6
    v_lshlrev_b32 v14, 7, v7
    v_xor_b32 v15, 0x400, v14
    s_and_b32 s15, s16, 7
    s_lshl_b32 s16, s16, 7
    v_mov_b32 v7, s16
    s_add_u32 s24, s4, 67108864
    s_addc_u32 s25, s5, 0
    s_cmp_eq_u32 s15, 3
    s_cselect_b64 vcc, -1, 0
    s_cselect_b32 s24, s24, s48
    s_cselect_b32 s25, s25, s49
    s_mov_b32 s26, 7340032
    s_mov_b32 s27, 0x20000
    v_cndmask_b32 v14, v7, v14, vcc
    v_cndmask_b32 v15, v7, v15, vcc
    v_add_u32 v10, v4, v14
    v_add_u32 v11, v5, v15
    s_xor_b32 s16, s11, 1
    s_and_b32 s19, s16, 8
    v_add_u32 v7, s19, v6
    v_lshlrev_b32 v14, 7, v7
    v_xor_b32 v15, 0x400, v14
    s_and_b32 s15, s16, 7
    s_lshl_b32 s16, s16, 7
    v_mov_b32 v7, s16
    s_add_u32 s32, s4, 67108864
    s_addc_u32 s33, s5, 0
    s_cmp_eq_u32 s15, 3
    s_cselect_b64 vcc, -1, 0
    s_cselect_b32 s32, s32, s48
    s_cselect_b32 s33, s33, s49
    s_mov_b32 s34, 7340032
    s_mov_b32 s35, 0x20000
    v_cndmask_b32 v14, v7, v14, vcc
    v_cndmask_b32 v15, v7, v15, vcc
    v_add_u32 v12, v4, v14
    v_add_u32 v13, v5, v15
    s_lshl_b32 s44, s12, 11
    s_add_u32 s44, s44, 16384
    s_and_b32 s15, s9, 7
    s_cmp_eq_u32 s15, 7
    s_mov_b32 s38, 251658240
    s_cselect_b32 s38, 15, s38
    s_mov_b32 s39, 0
    s_cselect_b32 s39, 0, s39
    s_cmp_eq_u32 s15, 0
    s_mov_b32 s30, 4026531840
    s_cselect_b32 s30, 0, s30
    s_mov_b32 s31, 0
    s_cselect_b32 s31, 15728640, s31
    s_or_b64 s[38:39], s[38:39], s[30:31]
    s_cmp_lg_u32 s8, 0
    s_mov_b32 s30, 268435455
    s_cselect_b32 s30, 4026531840, s30
    s_mov_b32 s31, 0
    s_cselect_b32 s31, 16777215, s31
    s_andn2_b64 s[30:31], s[30:31], s[38:39]
    s_mul_i32 s15, s9, 7
    s_add_u32 s15, s15, 1
    s_lshr_b32 s36, s15, 1
    s_lshl_b64 s[28:29], 7, s36
    s_andn2_b64 s[30:31], s[30:31], s[28:29]
    s_mov_b32 s64, 1826206566
    s_mov_b32 s65, 13474614
    s_and_b64 s[28:29], s[30:31], s[64:65]
    s_andn2_b64 s[30:31], s[30:31], s[64:65]
    s_mul_i32 s15, s10, 1376256
    s_add_u32 s15, s15, 41943040
    s_add_u32 s20, s4, s15
    s_addc_u32 s21, s5, 0
    s_mov_b32 s22, 1376256
    s_mov_b32 s23, 0x20000
    s_lshl_b32 s42, s36, 17
    s_add_u32 m0, 65536, s44
    s_nop 0
    buffer_load_dwordx4 v10, s[24:27], s42 offen lds
    buffer_load_dwordx4 v11, s[24:27], s42 offen offset:1024 lds
    s_add_u32 m0, m0, 8192
    s_nop 0
    buffer_load_dwordx4 v12, s[32:35], s42 offen lds
    buffer_load_dwordx4 v13, s[32:35], s42 offen offset:1024 lds
    s_add_u32 s42, s42, 131072
    s_add_u32 m0, 98304, s44
    s_nop 0
    buffer_load_dwordx4 v10, s[24:27], s42 offen lds
    buffer_load_dwordx4 v11, s[24:27], s42 offen offset:1024 lds
    s_add_u32 m0, m0, 8192
    s_nop 0
    buffer_load_dwordx4 v12, s[32:35], s42 offen lds
    buffer_load_dwordx4 v13, s[32:35], s42 offen offset:1024 lds
    s_add_u32 s42, s42, 131072
    s_add_u32 m0, 0, s44
    s_nop 0
    buffer_load_dwordx4 v10, s[24:27], s42 offen lds
    buffer_load_dwordx4 v11, s[24:27], s42 offen offset:1024 lds
    s_add_u32 m0, m0, 8192
    s_nop 0
    buffer_load_dwordx4 v12, s[32:35], s42 offen lds
    buffer_load_dwordx4 v13, s[32:35], s42 offen offset:1024 lds
    s_add_u32 s42, s42, 131072
    s_lshl_b32 s15, s10, 11
    s_add_u32 s15, s15, 32768
    s_lshl_b32 s61, s8, 3
    v_min_u32 v17, 7, v1
    v_add_u32 v17, s61, v17
    v_lshlrev_b32 v17, 7, v17
    s_barrier
    s_ff1_i32_b64 s61, s[28:29]
    s_bitset0_b64 s[28:29], s61
    s_lshl_b32 s42, s61, 17
    s_mul_i32 s41, s61, 3072
    s_add_u32 m0, 32768, s44
    s_nop 0
    buffer_load_dwordx4 v10, s[24:27], s42 offen lds
    buffer_load_dwordx4 v11, s[24:27], s42 offen offset:1024 lds
    s_add_u32 m0, m0, 8192
    s_nop 0
    buffer_load_dwordx4 v12, s[32:35], s42 offen lds
    buffer_load_dwordx4 v13, s[32:35], s42 offen offset:1024 lds
    s_add_u32 s42, s42, 131072
    s_barrier
    s_cmp_lg_u32 s12, 0
    s_cbranch_scc1 m_kernel_noa
    buffer_store_dword v20, v21, s[52:55], s14 offen sc1
m_kernel_noa:
    s_waitcnt vmcnt(4)
    s_barrier
    s_barrier
    buffer_load_dword v38, v17, s[52:55], s15 offen sc1
    s_barrier
    s_waitcnt vmcnt(0)
    v_cmp_ne_u32 vcc, 1, v38
    s_cbranch_vccz m_kernel_fl2_go
    s_mov_b32 s47, 400000
m_kernel_fl2_spin:
    buffer_load_dword v36, v17, s[52:55], s15 offen sc1
    s_waitcnt vmcnt(0)
    v_cmp_ne_u32 vcc, 1, v36
    s_cbranch_vccz m_kernel_fl2_go
    s_sleep 1
    s_sub_u32 s47, s47, 1
    s_cbranch_scc0 m_kernel_fl2_spin
m_kernel_fl2_go:
    s_add_u32 m0, 32768, s43
    s_nop 0
    buffer_load_dwordx4 v8, s[20:23], s41 offen sc1 lds
    buffer_load_dwordx4 v26, s[20:23], s41 offen offset:1024 sc1 lds
    s_add_u32 m0, m0, 2048
    s_nop 0
    buffer_load_dwordx4 v9, s[20:23], s41 offen sc1 lds
    buffer_load_dwordx4 v27, s[20:23], s41 offen offset:1024 sc1 lds
    s_add_u32 s41, s41, 3072
    s_mov_b32 s40, 65536
    s_ff1_i32_b64 s61, s[28:29]
    s_bitset0_b64 s[28:29], s61
    s_mul_i32 s41, s61, 3072
    s_lshl_b32 s42, s61, 17
    s_add_u32 m0, s40, s43
    s_nop 0
    buffer_load_dwordx4 v8, s[20:23], s41 offen sc1 lds
    buffer_load_dwordx4 v26, s[20:23], s41 offen offset:1024 sc1 lds
    s_add_u32 m0, m0, 2048
    s_nop 0
    buffer_load_dwordx4 v9, s[20:23], s41 offen sc1 lds
    buffer_load_dwordx4 v27, s[20:23], s41 offen offset:1024 sc1 lds
    s_add_u32 s41, s41, 3072
    s_add_u32 m0, s40, s44
    s_nop 0
    buffer_load_dwordx4 v10, s[24:27], s42 offen lds
    buffer_load_dwordx4 v11, s[24:27], s42 offen offset:1024 lds
    s_add_u32 m0, m0, 8192
    s_nop 0
    buffer_load_dwordx4 v12, s[32:35], s42 offen lds
    buffer_load_dwordx4 v13, s[32:35], s42 offen offset:1024 lds
    s_add_u32 s42, s42, 131072
    s_add_u32 s40, s40, 32768
    s_cmp_eq_u32 s40, 131072
    s_cselect_b32 s40, 0, s40
    s_ff1_i32_b64 s61, s[28:29]
    s_bitset0_b64 s[28:29], s61
    s_mul_i32 s41, s61, 3072
    s_lshl_b32 s42, s61, 17
    s_add_u32 m0, s40, s43
    s_nop 0
    buffer_load_dwordx4 v8, s[20:23], s41 offen sc1 lds
    buffer_load_dwordx4 v26, s[20:23], s41 offen offset:1024 sc1 lds
    s_add_u32 m0, m0, 2048
    s_nop 0
    buffer_load_dwordx4 v9, s[20:23], s41 offen sc1 lds
    buffer_load_dwordx4 v27, s[20:23], s41 offen offset:1024 sc1 lds
    s_add_u32 s41, s41, 3072
    s_add_u32 m0, s40, s44
    s_nop 0
    buffer_load_dwordx4 v10, s[24:27], s42 offen lds
    buffer_load_dwordx4 v11, s[24:27], s42 offen offset:1024 lds
    s_add_u32 m0, m0, 8192
    s_nop 0
    buffer_load_dwordx4 v12, s[32:35], s42 offen lds
    buffer_load_dwordx4 v13, s[32:35], s42 offen offset:1024 lds
    s_add_u32 s42, s42, 131072
    s_add_u32 s40, s40, 32768
    s_cmp_eq_u32 s40, 131072
    s_cselect_b32 s40, 0, s40
    s_waitcnt vmcnt(16)
    s_barrier
    s_mov_b32 s18, 2
m_kernel_l2a:
    s_ff1_i32_b64 s61, s[28:29]
    s_bitset0_b64 s[28:29], s61
    s_mul_i32 s41, s61, 3072
    s_lshl_b32 s42, s61, 17
    s_add_u32 m0, s40, s43
    s_nop 0
    buffer_load_dwordx4 v8, s[20:23], s41 offen sc1 lds
    buffer_load_dwordx4 v26, s[20:23], s41 offen offset:1024 sc1 lds
    s_add_u32 m0, m0, 2048
    s_nop 0
    buffer_load_dwordx4 v9, s[20:23], s41 offen sc1 lds
    buffer_load_dwordx4 v27, s[20:23], s41 offen offset:1024 sc1 lds
    s_add_u32 s41, s41, 3072
    s_add_u32 m0, s40, s44
    s_nop 0
    buffer_load_dwordx4 v10, s[24:27], s42 offen lds
    buffer_load_dwordx4 v11, s[24:27], s42 offen offset:1024 lds
    s_add_u32 m0, m0, 8192
    s_nop 0
    buffer_load_dwordx4 v12, s[32:35], s42 offen lds
    buffer_load_dwordx4 v13, s[32:35], s42 offen offset:1024 lds
    s_add_u32 s42, s42, 131072
    s_add_u32 s40, s40, 32768
    s_cmp_eq_u32 s40, 131072
    s_cselect_b32 s40, 0, s40
    s_sub_u32 s18, s18, 1
    s_cmp_lg_u32 s18, 0
    s_waitcnt vmcnt(16)
    s_barrier
    s_cbranch_scc1 m_kernel_l2a
    s_cmp_lg_u32 s12, 0
    s_cbranch_scc1 m_kernel_nob
    s_add_u32 s14, s14, 163840
    buffer_store_dword v20, v21, s[52:55], s14 offen sc1
m_kernel_nob:
    s_mov_b32 s18, 6
m_kernel_l2b:
    s_ff1_i32_b64 s61, s[28:29]
    s_bitset0_b64 s[28:29], s61
    s_mul_i32 s41, s61, 3072
    s_lshl_b32 s42, s61, 17
    s_add_u32 m0, s40, s43
    s_nop 0
    buffer_load_dwordx4 v8, s[20:23], s41 offen sc1 lds
    buffer_load_dwordx4 v26, s[20:23], s41 offen offset:1024 sc1 lds
    s_add_u32 m0, m0, 2048
    s_nop 0
    buffer_load_dwordx4 v9, s[20:23], s41 offen sc1 lds
    buffer_load_dwordx4 v27, s[20:23], s41 offen offset:1024 sc1 lds
    s_add_u32 s41, s41, 3072
    s_add_u32 m0, s40, s44
    s_nop 0
    buffer_load_dwordx4 v10, s[24:27], s42 offen lds
    buffer_load_dwordx4 v11, s[24:27], s42 offen offset:1024 lds
    s_add_u32 m0, m0, 8192
    s_nop 0
    buffer_load_dwordx4 v12, s[32:35], s42 offen lds
    buffer_load_dwordx4 v13, s[32:35], s42 offen offset:1024 lds
    s_add_u32 s42, s42, 131072
    s_add_u32 s40, s40, 32768
    s_cmp_eq_u32 s40, 131072
    s_cselect_b32 s40, 0, s40
    s_sub_u32 s18, s18, 1
    s_cmp_lg_u32 s18, 0
    s_waitcnt vmcnt(16)
    s_barrier
    s_cbranch_scc1 m_kernel_l2b
    s_add_u32 s15, s15, 163840
    v_and_b32 v17, 15, v1
    v_lshlrev_b32 v17, 7, v17
    buffer_load_dword v36, v17, s[52:55], s15 offen sc1
    s_ff1_i32_b64 s61, s[28:29]
    s_bitset0_b64 s[28:29], s61
    s_mul_i32 s41, s61, 3072
    s_lshl_b32 s42, s61, 17
    s_add_u32 m0, s40, s43
    s_nop 0
    buffer_load_dwordx4 v8, s[20:23], s41 offen sc1 lds
    buffer_load_dwordx4 v26, s[20:23], s41 offen offset:1024 sc1 lds
    s_add_u32 m0, m0, 2048
    s_nop 0
    buffer_load_dwordx4 v9, s[20:23], s41 offen sc1 lds
    buffer_load_dwordx4 v27, s[20:23], s41 offen offset:1024 sc1 lds
    s_add_u32 s41, s41, 3072
    s_add_u32 m0, s40, s44
    s_nop 0
    buffer_load_dwordx4 v10, s[24:27], s42 offen lds
    buffer_load_dwordx4 v11, s[24:27], s42 offen offset:1024 lds
    s_add_u32 m0, m0, 8192
    s_nop 0
    buffer_load_dwordx4 v12, s[32:35], s42 offen lds
    buffer_load_dwordx4 v13, s[32:35], s42 offen offset:1024 lds
    s_add_u32 s42, s42, 131072
    s_add_u32 s40, s40, 32768
    s_cmp_eq_u32 s40, 131072
    s_cselect_b32 s40, 0, s40
    s_waitcnt vmcnt(16)
    s_barrier
    s_waitcnt vmcnt(8)
    v_cmp_ne_u32 vcc, 1, v36
    s_cbranch_vccz m_kernel_fl4_go
    s_mov_b32 s47, 400000
m_kernel_fl4_spin:
    buffer_load_dword v36, v17, s[52:55], s15 offen sc1
    s_waitcnt vmcnt(0)
    v_cmp_ne_u32 vcc, 1, v36
    s_cbranch_vccz m_kernel_fl4_go
    s_sleep 1
    s_sub_u32 s47, s47, 1
    s_cbranch_scc0 m_kernel_fl4_spin
m_kernel_fl4_go:
    s_mov_b32 s18, 9
m_kernel_l2c:
    s_ff1_i32_b64 s61, s[30:31]
    s_bitset0_b64 s[30:31], s61
    s_mul_i32 s41, s61, 3072
    s_lshl_b32 s42, s61, 17
    s_add_u32 m0, s40, s43
    s_nop 0
    buffer_load_dwordx4 v8, s[20:23], s41 offen sc1 lds
    buffer_load_dwordx4 v26, s[20:23], s41 offen offset:1024 sc1 lds
    s_add_u32 m0, m0, 2048
    s_nop 0
    buffer_load_dwordx4 v9, s[20:23], s41 offen sc1 lds
    buffer_load_dwordx4 v27, s[20:23], s41 offen offset:1024 sc1 lds
    s_add_u32 s41, s41, 3072
    s_add_u32 m0, s40, s44
    s_nop 0
    buffer_load_dwordx4 v10, s[24:27], s42 offen lds
    buffer_load_dwordx4 v11, s[24:27], s42 offen offset:1024 lds
    s_add_u32 m0, m0, 8192
    s_nop 0
    buffer_load_dwordx4 v12, s[32:35], s42 offen lds
    buffer_load_dwordx4 v13, s[32:35], s42 offen offset:1024 lds
    s_add_u32 s42, s42, 131072
    s_add_u32 s40, s40, 32768
    s_cmp_eq_u32 s40, 131072
    s_cselect_b32 s40, 0, s40
    s_sub_u32 s18, s18, 1
    s_cmp_lg_u32 s18, 0
    s_waitcnt vmcnt(16)
    s_barrier
    s_cbranch_scc1 m_kernel_l2c
    s_ff1_i32_b64 s61, s[38:39]
    s_bitset0_b64 s[38:39], s61
    s_mul_i32 s41, s61, 3072
    s_lshl_b32 s42, s61, 17
    s_add_u32 m0, s40, s43
    s_nop 0
    buffer_load_dwordx4 v8, s[20:23], s41 offen sc1 lds
    buffer_load_dwordx4 v26, s[20:23], s41 offen offset:1024 sc1 lds
    s_add_u32 m0, m0, 2048
    s_nop 0
    buffer_load_dwordx4 v9, s[20:23], s41 offen sc1 lds
    buffer_load_dwordx4 v27, s[20:23], s41 offen offset:1024 sc1 lds
    s_add_u32 s41, s41, 3072
    s_add_u32 m0, s40, s44
    s_nop 0
    buffer_load_dwordx4 v10, s[24:27], s42 offen lds
    buffer_load_dwordx4 v11, s[24:27], s42 offen offset:1024 lds
    s_add_u32 s42, s42, 131072
    s_add_u32 s40, s40, 32768
    s_cmp_eq_u32 s40, 131072
    s_cselect_b32 s40, 0, s40
    s_waitcnt vmcnt(14)
    s_barrier
    s_ff1_i32_b64 s61, s[38:39]
    s_bitset0_b64 s[38:39], s61
    s_mul_i32 s41, s61, 3072
    s_lshl_b32 s42, s61, 17
    s_add_u32 m0, s40, s43
    s_nop 0
    buffer_load_dwordx4 v8, s[20:23], s41 offen sc1 lds
    buffer_load_dwordx4 v26, s[20:23], s41 offen offset:1024 sc1 lds
    s_add_u32 m0, m0, 2048
    s_nop 0
    buffer_load_dwordx4 v9, s[20:23], s41 offen sc1 lds
    buffer_load_dwordx4 v27, s[20:23], s41 offen offset:1024 sc1 lds
    s_add_u32 s41, s41, 3072
    s_add_u32 m0, s40, s44
    s_nop 0
    buffer_load_dwordx4 v10, s[24:27], s42 offen lds
    buffer_load_dwordx4 v11, s[24:27], s42 offen offset:1024 lds
    s_add_u32 s42, s42, 131072
    s_add_u32 s40, s40, 32768
    s_cmp_eq_u32 s40, 131072
    s_cselect_b32 s40, 0, s40
    s_waitcnt vmcnt(12)
    s_barrier
    s_ff1_i32_b64 s61, s[38:39]
    s_bitset0_b64 s[38:39], s61
    s_mul_i32 s41, s61, 3072
    s_lshl_b32 s42, s61, 17
    s_add_u32 m0, s40, s43
    s_nop 0
    buffer_load_dwordx4 v8, s[20:23], s41 offen sc1 lds
    buffer_load_dwordx4 v26, s[20:23], s41 offen offset:1024 sc1 lds
    s_add_u32 m0, m0, 2048
    s_nop 0
    buffer_load_dwordx4 v9, s[20:23], s41 offen sc1 lds
    buffer_load_dwordx4 v27, s[20:23], s41 offen offset:1024 sc1 lds
    s_add_u32 s41, s41, 3072
    s_add_u32 m0, s40, s44
    s_nop 0
    buffer_load_dwordx4 v10, s[24:27], s42 offen lds
    buffer_load_dwordx4 v11, s[24:27], s42 offen offset:1024 lds
    s_add_u32 s42, s42, 131072
    s_add_u32 s40, s40, 32768
    s_cmp_eq_u32 s40, 131072
    s_cselect_b32 s40, 0, s40
    s_waitcnt vmcnt(12)
    s_barrier
    s_ff1_i32_b64 s61, s[38:39]
    s_bitset0_b64 s[38:39], s61
    s_mul_i32 s41, s61, 3072
    s_lshl_b32 s42, s61, 17
    s_add_u32 m0, s40, s43
    s_nop 0
    buffer_load_dwordx4 v8, s[20:23], s41 offen sc1 lds
    buffer_load_dwordx4 v26, s[20:23], s41 offen offset:1024 sc1 lds
    s_add_u32 m0, m0, 2048
    s_nop 0
    buffer_load_dwordx4 v9, s[20:23], s41 offen sc1 lds
    buffer_load_dwordx4 v27, s[20:23], s41 offen offset:1024 sc1 lds
    s_add_u32 s41, s41, 3072
    s_add_u32 m0, s40, s44
    s_nop 0
    buffer_load_dwordx4 v10, s[24:27], s42 offen lds
    buffer_load_dwordx4 v11, s[24:27], s42 offen offset:1024 lds
    s_add_u32 s42, s42, 131072
    s_add_u32 s40, s40, 32768
    s_cmp_eq_u32 s40, 131072
    s_cselect_b32 s40, 0, s40
    s_waitcnt vmcnt(12)
    s_barrier
    s_ff1_i32_b64 s61, s[38:39]
    s_bitset0_b64 s[38:39], s61
    s_mul_i32 s41, s61, 3072
    s_lshl_b32 s42, s61, 17
    s_add_u32 m0, s40, s43
    s_nop 0
    buffer_load_dwordx4 v8, s[20:23], s41 offen sc1 lds
    buffer_load_dwordx4 v26, s[20:23], s41 offen offset:1024 sc1 lds
    s_add_u32 m0, m0, 2048
    s_nop 0
    buffer_load_dwordx4 v9, s[20:23], s41 offen sc1 lds
    buffer_load_dwordx4 v27, s[20:23], s41 offen offset:1024 sc1 lds
    s_add_u32 s41, s41, 3072
    s_add_u32 m0, s40, s44
    s_nop 0
    buffer_load_dwordx4 v10, s[24:27], s42 offen lds
    buffer_load_dwordx4 v11, s[24:27], s42 offen offset:1024 lds
    s_add_u32 s42, s42, 131072
    s_add_u32 s40, s40, 32768
    s_cmp_eq_u32 s40, 131072
    s_cselect_b32 s40, 0, s40
    s_waitcnt vmcnt(12)
    s_barrier
    s_ff1_i32_b64 s61, s[38:39]
    s_bitset0_b64 s[38:39], s61
    s_mul_i32 s41, s61, 3072
    s_lshl_b32 s42, s61, 17
    s_add_u32 m0, s40, s43
    s_nop 0
    buffer_load_dwordx4 v8, s[20:23], s41 offen sc1 lds
    buffer_load_dwordx4 v26, s[20:23], s41 offen offset:1024 sc1 lds
    s_add_u32 m0, m0, 2048
    s_nop 0
    buffer_load_dwordx4 v9, s[20:23], s41 offen sc1 lds
    buffer_load_dwordx4 v27, s[20:23], s41 offen offset:1024 sc1 lds
    s_add_u32 s41, s41, 3072
    s_add_u32 m0, s40, s44
    s_nop 0
    buffer_load_dwordx4 v10, s[24:27], s42 offen lds
    buffer_load_dwordx4 v11, s[24:27], s42 offen offset:1024 lds
    s_add_u32 s42, s42, 131072
    s_add_u32 s40, s40, 32768
    s_cmp_eq_u32 s40, 131072
    s_cselect_b32 s40, 0, s40
    s_waitcnt vmcnt(12)
    s_barrier
    s_ff1_i32_b64 s61, s[38:39]
    s_bitset0_b64 s[38:39], s61
    s_mul_i32 s41, s61, 3072
    s_lshl_b32 s42, s61, 17
    s_add_u32 m0, s40, s43
    s_nop 0
    buffer_load_dwordx4 v8, s[20:23], s41 offen sc1 lds
    buffer_load_dwordx4 v26, s[20:23], s41 offen offset:1024 sc1 lds
    s_add_u32 m0, m0, 2048
    s_nop 0
    buffer_load_dwordx4 v9, s[20:23], s41 offen sc1 lds
    buffer_load_dwordx4 v27, s[20:23], s41 offen offset:1024 sc1 lds
    s_add_u32 s41, s41, 3072
    s_add_u32 m0, s40, s44
    s_nop 0
    buffer_load_dwordx4 v10, s[24:27], s42 offen lds
    buffer_load_dwordx4 v11, s[24:27], s42 offen offset:1024 lds
    s_add_u32 s42, s42, 131072
    s_add_u32 s40, s40, 32768
    s_cmp_eq_u32 s40, 131072
    s_cselect_b32 s40, 0, s40
    s_waitcnt vmcnt(12)
    s_barrier
    s_ff1_i32_b64 s61, s[38:39]
    s_bitset0_b64 s[38:39], s61
    s_mul_i32 s41, s61, 3072
    s_lshl_b32 s42, s61, 17
    s_add_u32 m0, s40, s43
    s_nop 0
    buffer_load_dwordx4 v8, s[20:23], s41 offen sc1 lds
    buffer_load_dwordx4 v26, s[20:23], s41 offen offset:1024 sc1 lds
    s_add_u32 m0, m0, 2048
    s_nop 0
    buffer_load_dwordx4 v9, s[20:23], s41 offen sc1 lds
    buffer_load_dwordx4 v27, s[20:23], s41 offen offset:1024 sc1 lds
    s_add_u32 s41, s41, 3072
    s_add_u32 m0, s40, s44
    s_nop 0
    buffer_load_dwordx4 v10, s[24:27], s42 offen lds
    buffer_load_dwordx4 v11, s[24:27], s42 offen offset:1024 lds
    s_add_u32 s42, s42, 131072
    s_add_u32 s40, s40, 32768
    s_cmp_eq_u32 s40, 131072
    s_cselect_b32 s40, 0, s40
    s_waitcnt vmcnt(12)
    s_barrier
    s_waitcnt vmcnt(6)
    s_barrier
    s_waitcnt vmcnt(0)
    s_barrier
m_kernel_end:
    s_endpgm
.p2align 7
CODE_END:
.section .rodata,"a"
.p2align 6
.amdhsa_kernel fa_kernel
  .amdhsa_next_free_vgpr 256
  .amdhsa_next_free_sgpr 100
  .amdhsa_accum_offset 256
  .amdhsa_group_segment_fixed_size 0
  .amdhsa_kernarg_size 104
  .amdhsa_user_sgpr_count 2
  .amdhsa_user_sgpr_kernarg_segment_ptr 1
  .amdhsa_system_sgpr_workgroup_id_x 1
  .amdhsa_float_denorm_mode_32 3
.end_amdhsa_kernel
.p2align 6
.amdhsa_kernel m_kernel
  .amdhsa_next_free_vgpr 256
  .amdhsa_next_free_sgpr 100
  .amdhsa_accum_offset 256
  .amdhsa_group_segment_fixed_size 0
  .amdhsa_kernarg_size 104
  .amdhsa_user_sgpr_count 2
  .amdhsa_user_sgpr_kernarg_segment_ptr 1
  .amdhsa_system_sgpr_workgroup_id_x 1
  .amdhsa_float_denorm_mode_32 3
.end_amdhsa_kernel
```
